```python
import torch

def _softmax(x, axis=-1):
    return torch.softmax(x, dim=axis)
def _gelu(x):
    return torch.nn.functional.gelu(x, approximate="tanh")
def _silu(x):
    return torch.nn.functional.silu(x)
def _sigmoid(x):
    return torch.sigmoid(x)
def _layernorm(x, axis=-1, eps=1e-5):
    m = x.mean(dim=axis, keepdim=True)
    v = x.var(dim=axis, keepdim=True, unbiased=False)
    return (x - m) / torch.sqrt(v + eps)
def _scatter_add(tgt, idx, src, axis=0):
    return tgt.clone().index_add_(axis, idx, src)
def _segment_sum(src, seg, n):
    out = torch.zeros((n,) + src.shape[1:], dtype=src.dtype)
    return out.index_add_(0, seg, src)
def _pad(x, pw):
    flat = tuple(v for pair in reversed(pw) for v in pair)
    return torch.nn.functional.pad(x, flat)

kernel_name = 'concat_heads__ssm_conv_s4__linear_kernel_hedgehog__prompt'

def setup_inputs():

    _w = (lambda a: (lambda t: t.to(torch.bfloat16) if t.is_floating_point() else t)(torch.as_tensor(a)))
    def _A_setup():
        B, L, D, N = 1, 2048, 640, 192
        A_re = -(lambda _x: torch.exp(torch.as_tensor(_x)))((lambda *s: torch.randn(*s, dtype=torch.bfloat16) * 3.2)(D, N))
        A_im = torch.pi * (lambda *s: torch.randn(*s, dtype=torch.bfloat16) * 0.2)(D, N)
        B_re = (lambda *s: torch.randn(*s, dtype=torch.bfloat16) * 0.4)(D, N)
        B_im = (lambda *s: torch.randn(*s, dtype=torch.bfloat16) * 0.4)(D, N)
        C_re = (lambda *s: torch.randn(*s, dtype=torch.bfloat16) * 0.4)(D, N)
        C_im = (lambda *s: torch.randn(*s, dtype=torch.bfloat16) * 0.4)(D, N)
        log_dt = (lambda *s: torch.randn(*s, dtype=torch.bfloat16) * 0.2)(D) * 0.5 - 4.0
        Dskip = (lambda *s: torch.randn(*s, dtype=torch.bfloat16) * 0.4)(D)
        return {
            "u": _w((lambda *s: torch.randn(*s, dtype=torch.bfloat16) * 0.05)(B, L, D)),
            "A_re": _w(A_re),
            "A_im": _w(A_im),
            "B_re": _w(B_re),
            "B_im": _w(B_im),
            "C_re": _w(C_re),
            "C_im": _w(C_im),
            "log_dt": _w(log_dt),
            "Dskip": _w(Dskip),
        }
    _A_in = _A_setup()

    def _B_setup():
        B, S, D, H = 1, 2048, 640, 32
        Dh = D // H
        return {
            "x": _w((lambda *s: torch.randn(*s, dtype=torch.bfloat16) * 0.4)(B, S, D)),
            "wqkv": _w((lambda *s: torch.randn(*s, dtype=torch.bfloat16) * 0.4)(D, 3 * D)),
            "w_phi": _w((lambda *s: torch.randn(*s, dtype=torch.bfloat16) * 0.4)(H, Dh, Dh) * (Dh ** -0.5)),
            "wo": _w((lambda *s: torch.randn(*s, dtype=torch.bfloat16) * 0.05)(D, D)),
        }
    _B_in = _B_setup()

    return {
        "A_u": _A_in["u"],
        "A_A_re": _A_in["A_re"],
        "A_A_im": _A_in["A_im"],
        "A_B_re": _A_in["B_re"],
        "A_B_im": _A_in["B_im"],
        "A_C_re": _A_in["C_re"],
        "A_C_im": _A_in["C_im"],
        "A_log_dt": _A_in["log_dt"],
        "A_Dskip": _A_in["Dskip"],
        "B_x": _B_in["x"],
        "B_wqkv": _B_in["wqkv"],
        "B_w_phi": _B_in["w_phi"],
        "B_wo": _B_in["wo"],
    }

def reference(A_u, A_A_re, A_A_im, A_B_re, A_B_im, A_C_re, A_C_im, A_log_dt, A_Dskip, B_x, B_wqkv, B_w_phi, B_wo):
    def _A_ref(u, A_re, A_im, B_re, B_im, C_re, C_im, log_dt, Dskip):
        Bsz, L, D = u.shape
        dt = torch.exp(log_dt)[:, None]
        A = A_re + 1j * A_im
        Bc = B_re + 1j * B_im
        Cc = C_re + 1j * C_im
        logdA = dt * A
        dB = dt * Bc
        l = (lambda x, dt: x.to(dt))(torch.arange(L), A_re.dtype)
        P = torch.exp(logdA[:, :, None] * l[None, None, :])
        K = torch.einsum("dn,dnl,dn->dl", Cc, P, dB).real
        L2 = 2 * L
        Kp = _pad(K, ((0, 0), (0, L)))
        up = (lambda x, *d: x.permute(*d))(u, 0, 2, 1)
        up = _pad(up, ((0, 0), (0, 0), (0, L)))
        Kf = (lambda x, axes=(-2,-1): torch.fft.rfft2(x.float(), dim=axes))(Kp[:, None, :], axes=(-2, -1))
        Uf = (lambda x, axes=(-2,-1): torch.fft.rfft2(x.float(), dim=axes))(up[:, :, None, :], axes=(-2, -1))
        Yf = Uf * Kf[None, :, :, :]
        y = (lambda x, s, axes=(-2,-1): torch.fft.irfft2(x, s=s, dim=axes).to(torch.bfloat16))(Yf, (1, L2), axes=(-2, -1))[:, :, 0, :L]
        y = (lambda x, *d: x.permute(*d))(y, 0, 2, 1) + u * Dskip[None, None, :]
        return y

    def _B_ref(x, wqkv, w_phi, wo):
        B, S, D = x.shape
        H = 32; Dh = D // H
        qkv = (lambda x, *d: x.permute(*d))((x @ wqkv).reshape(B, S, 3, H, Dh), 2, 0, 3, 1, 4)
        q, k, v = qkv[0], qkv[1], qkv[2]
        pq = torch.einsum("bhsd,hdf->bhsf", q, w_phi)
        pk = torch.einsum("bhsd,hdf->bhsf", k, w_phi)
        phi_q = torch.concatenate([_softmax(pq, axis=-1), _softmax(-pq, axis=-1)], axis=-1)
        phi_k = torch.concatenate([_softmax(pk, axis=-1), _softmax(-pk, axis=-1)], axis=-1)
        kv = torch.einsum("bhsf,bhsd->bhfd", phi_k, v)
        z  = torch.einsum("bhsf->bhf", phi_k)
        num = torch.einsum("bhqf,bhfd->bhqd", phi_q, kv)
        den = torch.einsum("bhqf,bhf->bhq", phi_q, z)[..., None] + 1e-6
        o = num / den
        return (lambda x, *d: x.permute(*d))(o, 0, 2, 1, 3).reshape(B, S, D) @ wo

    a = _A_ref(A_u, A_A_re, A_A_im, A_B_re, A_B_im, A_C_re, A_C_im, A_log_dt, A_Dskip)
    b = _B_ref(B_x, B_wqkv, B_w_phi, B_wo)
    return torch.concatenate([a, b], axis=-1)
```

```asm
; @launch grid=(256,1,1) block=(512,1,1) lds=163840
.amdgcn_target "amdgcn-amd-amdhsa--gfx950"
.text
.globl concat_heads__ssm_conv_s4__linear_kernel_hedgehog__prompt_kernel
.p2align 8
.type concat_heads__ssm_conv_s4__linear_kernel_hedgehog__prompt_kernel,@function
concat_heads__ssm_conv_s4__linear_kernel_hedgehog__prompt_kernel:
    s_cmp_ge_u32 s2, 256
    s_cbranch_scc1 L_END
    s_cmp_lt_u32 s2, 176
    s_cselect_b32 s7, 64, 0
    s_load_dwordx16 s[8:23], s[0:1], s7
    s_load_dwordx2 s[24:25], s[0:1], 64
    s_load_dwordx2 s[64:65], s[0:1], 72
    s_load_dwordx2 s[26:27], s[0:1], 104
    s_load_dwordx2 s[62:63], s[0:1], 120
    s_load_dwordx2 s[36:37], s[0:1], 112
    v_lshrrev_b32 v2, 6, v0
    v_and_b32 v1, 63, v0
    v_readfirstlane_b32 s4, v2
    s_and_b32 s5, s2, 7
    s_lshr_b32 s6, s2, 3
    s_cmp_lg_u32 s4, 7
    s_cbranch_scc1 L_NOCPF
    s_getpc_b64 s[50:51]
L_PC:
    s_mul_i32 s7, s6, 1280
    v_lshl_add_u32 v3, v1, 7, s7
    v_min_u32 v3, L_END - L_PC, v3
    v_mov_b32 v5, s51
    v_add_co_u32 v4, vcc, s50, v3
    s_nop 1
    v_addc_co_u32 v5, vcc, 0, v5, vcc
    s_mov_b64 exec, 0x3ff
    global_load_dword v100, v[4:5], off
L_NOCPF:
    s_mov_b64 exec, -1
    s_cmp_lt_u32 s2, 176
    s_cbranch_scc1 L_ROLE_B
    s_mul_i32 s7, s5, 10
    s_add_u32 s7, s7, s6
    s_sub_u32 s7, s7, 22
    s_sub_u32 s29, s6, 22
    s_lshl_b32 s28, s5, 3
    s_lshl_b32 s30, s5, 1
    s_add_u32 s30, s30, 56
    s_cmp_lt_u32 s29, 8
    s_cselect_b32 s28, s28, s30
    s_add_u32 s28, s28, s29
    s_lshl_b32 s28, s28, 3
    s_add_u32 s29, s28, s4
    s_mul_i32 s30, s29, 384
    s_lshr_b32 s31, s29, 1
    s_lshl_b32 s31, s31, 2
    v_lshl_add_u32 v2, v1, 2, s30
    v_lshl_add_u32 v3, v1, 1, s30
    v_mov_b32 v14, 0
    v_mov_b32 v15, 0
    v_mov_b32 v16, 0
    v_mov_b32 v17, 0
    v_mov_b32 v18, 0
    v_mov_b32_e64 v19, 0
    s_waitcnt lgkmcnt(0)
    s_load_dword s48, s[22:23], s31
    s_load_dword s49, s[24:25], s31
    global_load_dword v8, v2, s[10:11]
    global_load_dword v9, v2, s[12:13]
    global_load_dword v10, v2, s[14:15]
    global_load_dword v11, v2, s[16:17]
    global_load_dword v12, v2, s[18:19]
    global_load_dword v13, v2, s[20:21]
    global_load_short_d16_hi v14, v3, s[10:11] offset:256
    global_load_short_d16_hi v15, v3, s[12:13] offset:256
    global_load_short_d16_hi v16, v3, s[14:15] offset:256
    global_load_short_d16_hi v17, v3, s[16:17] offset:256
    global_load_short_d16_hi v18, v3, s[18:19] offset:256
    global_load_short_d16_hi v19, v3, s[20:21] offset:256
    s_branch L_ROLE_A
L_ROLE_B:
    v_mov_b32 v14, 163824
    v_mov_b32 v15, 0
    ds_write2_b32 v14, v15, v15 offset1:1
    v_mov_b32 v13, 163584
    ds_write2_b32 v13, v15, v15 offset1:1
    ds_write2_b32 v13, v15, v15 offset0:20 offset1:21
    s_lshr_b32 s7, s6, 1
    s_and_b32 s50, s6, 1
    s_lshl_b32 s51, s5, 1
    s_add_u32 s3, s50, s51
    s_min_u32 s50, s6, 19
    s_mul_i32 s51, s50, 52
    s_lshr_b32 s51, s51, 8
    s_mul_i32 s52, s51, 5
    s_sub_u32 s49, s50, s52
    s_lshl_b32 s50, s5, 2
    s_add_u32 s48, s50, s51
    s_mov_b32 s60, 0x3fb8aa3b
    s_mov_b32 s61, 0xbfb8aa3b
    s_getreg_b32 s67, hwreg(HW_REG_XCC_ID, 0, 4)
    s_or_b32 s67, s67, 0x80
    s_lshl_b32 s68, s5, 5
    s_nop 0
    s_mov_b32 s30, 2457600
    s_mov_b32 s31, 0x20000
    s_mov_b32 s42, 7340032
    s_mov_b32 s43, 0x20000
    s_mul_i32 s59, s5, 1
    s_mul_i32 s50, s7, 1
    s_add_u32 s59, s59, s50
    s_mul_i32 s50, s59, 205
    s_lshr_b32 s50, s50, 11
    s_mul_i32 s50, s50, 10
    s_sub_u32 s59, s59, s50
    s_cmp_ge_u32 s4, 4
    s_cbranch_scc1 B_LOAD
    s_lshr_b32 s52, s4, 1
    s_and_b32 s53, s4, 1
    v_add_u32_e64 v4, 0, v1
    v_mul_u32_u24 v5, 205, v4
    v_lshrrev_b32 v5, 10, v5
    v_mul_u32_u24 v6, 5, v5
    v_sub_u32 v4, v4, v6
    v_lshlrev_b32 v4, 4, v4
    v_lshrrev_b32_e64 v6, 3, v5
    v_mul_u32_u24 v6, 1280, v6
    v_add_u32_e64 v4, v4, v6
    v_bfe_u32 v6, v5, 1, 2
    v_and_b32_e64 v5, 1, v5
    v_lshl_add_u32 v5, v5, 2, v6
    v_mul_u32_u24 v5, 3840, v5
    v_add_u32 v8, v4, v5
    v_add_u32 v4, 64, v1
    v_mul_u32_u24 v5, 205, v4
    v_lshrrev_b32 v5, 10, v5
    v_mul_u32_u24 v6, 5, v5
    v_sub_u32 v4, v4, v6
    v_lshlrev_b32 v4, 4, v4
    v_lshrrev_b32_e64 v6, 3, v5
    v_mul_u32_u24 v6, 1280, v6
    v_add_u32_e64 v4, v4, v6
    v_bfe_u32 v6, v5, 1, 2
    v_and_b32_e64 v5, 1, v5
    v_lshl_add_u32 v5, v5, 2, v6
    v_mul_u32_u24 v5, 3840, v5
    v_add_u32_e64 v9, v4, v5
    s_lshl_b32 s54, s6, 2
    s_add_u32 s54, s54, s4
    s_mul_i32 s50, s54, 30720
    s_mul_i32 s51, s5, 160
    s_add_u32 s50, s50, s51
    v_mov_b32 v4, 0x7fffffff
    v_cmp_gt_u32 vcc, 56, v1
    s_nop 1
    v_cndmask_b32_e64 v9, v4, v9, vcc
    s_lshl_b32 s66, s4, 10
    s_add_u32 s66, s66, 119808
    s_mov_b32 m0, s66
    v_min_u32 v10, 49, v1
    v_lshlrev_b32_e64 v10, 4, v10
    s_lshl_b32 s55, s3, 1
    s_add_u32 s55, s55, s53
    s_mul_i32 s55, s55, 800
    s_mov_b32 s34, 25600
    s_mov_b32 s35, 0x20000
    s_waitcnt lgkmcnt(0)
    s_mov_b64 s[28:29], s[12:13]
    s_mov_b64 s[40:41], s[22:23]
    s_nop 0
    buffer_load_dwordx4 v[88:91], v8, s[28:31], s50 offen offset:0
    buffer_load_dwordx4 v[92:95], v8, s[28:31], s50 offen offset:80
    buffer_load_dwordx4 v[96:99], v9, s[28:31], s50 offen offset:0
    buffer_load_dwordx4 v[100:103], v9, s[28:31], s50 offen offset:80
    s_mov_b64 s[32:33], s[14:15]
    buffer_load_dwordx4 v10, s[32:35], s55 offen lds
    s_barrier
    s_mul_i32 s50, s53, 11
    s_add_u32 s50, s50, s7
    s_lshl_b32 s50, s50, 2
    s_lshl_b32 s51, s3, 7
    s_add_u32 s50, s50, s51
    s_add_u32 s50, s50, 40960
    s_mov_b64 exec, 1
    buffer_store_dword v15, v15, s[40:43], s50 offen
    s_mov_b64 exec, -1
    s_add_u32 s44, s22, 4194432
    s_addc_u32 s45, s23, 0
    s_mov_b32 s46, 2621440
    s_mov_b32 s47, 0x20000
    s_mul_i32 s56, s54, 1920
    s_mul_i32 s51, s5, 307200
    s_add_u32 s56, s56, s51
    s_add_u32 s56, s56, 1572864
    s_add_u32 s57, s56, 153600
    v_lshlrev_b32 v87, 4, v1
    v_mov_b32 v86, v14
    v_and_b32 v2, 31, v1
    v_lshrrev_b32 v3, 5, v1
    v_lshrrev_b32 v4, 3, v2
    v_and_b32_e64 v5, 3, v2
    v_lshl_add_u32 v4, v4, 2, v5
    v_bfe_u32 v5, v2, 2, 1
    v_cmp_gt_u32 s[64:65], 10, v4
    v_mad_u32_u24 v4, v5, 10, v4
    v_lshl_add_u32 v4, v4, 1, s66
    s_lshl_b32 s50, s3, 1
    s_add_u32 s54, s50, s53
    s_mul_i32 s51, s53, 160
    s_mul_i32 s55, s53, 640
    s_sub_u32 s50, 640, s55
    v_mul_u32_u24 v5, 160, v3
    v_add3_u32 v85, v5, v4, s51
    v_add_u32 v84, s50, v4
    v_and_b32 v6, 1, v1
    v_lshlrev_b32_e64 v6, 4, v6
    v_mov_b32 v7, 0x3f80
    v_lshlrev_b32 v6, v6, v7
    v_lshrrev_b32 v7, 1, v2
    v_lshlrev_b32 v48, 1, v3
    v_sub_u32 v7, v7, v48
    v_cmp_eq_u32 vcc, 0, v7
    s_nop 1
    v_cndmask_b32 v32, 0, v6, vcc
    v_cmp_eq_u32 vcc, 1, v7
    s_nop 1
    v_cndmask_b32 v33, 0, v6, vcc
    v_cmp_eq_u32 vcc, 4, v7
    s_nop 1
    v_cndmask_b32 v34, 0, v6, vcc
    v_cmp_eq_u32 vcc, 5, v7
    s_nop 1
    v_cndmask_b32 v35, 0, v6, vcc
    v_cmp_eq_u32 vcc, 4, v7
    s_nop 1
    v_cndmask_b32 v40, 0, v6, vcc
    v_cmp_eq_u32 vcc, 5, v7
    s_nop 1
    v_cndmask_b32 v41, 0, v6, vcc
    v_cmp_eq_u32 vcc, 8, v7
    s_nop 1
    v_cndmask_b32 v42, 0, v6, vcc
    v_cmp_eq_u32 vcc, 9, v7
    s_nop 1
    v_cndmask_b32 v43, 0, v6, vcc
    v_cmp_eq_u32 vcc, 8, v7
    s_nop 1
    v_cndmask_b32 v36, 0, v6, vcc
    v_cmp_eq_u32 vcc, 9, v7
    s_nop 1
    v_cndmask_b32 v37, 0, v6, vcc
    v_cmp_eq_u32 vcc, 12, v7
    s_nop 1
    v_cndmask_b32 v38, 0, v6, vcc
    v_cmp_eq_u32 vcc, 13, v7
    s_nop 1
    v_cndmask_b32 v39, 0, v6, vcc
    v_mov_b32 v44, 0
    v_mov_b32 v45, 0
    v_lshrrev_b32 v7, 1, v1
    v_cmp_eq_u32 vcc, 12, v7
    s_nop 1
    v_cndmask_b32 v46, 0, v6, vcc
    v_cmp_eq_u32 vcc, 14, v7
    s_nop 1
    v_cndmask_b32 v47, 0, v6, vcc
    v_or_b32 v7, 4, v1
    v_cmp_eq_u32 vcc, 62, v7
    s_nop 1
    v_cndmask_b32 v46, v46, v6, vcc
    v_and_b32 v4, 15, v1
    v_lshrrev_b32_e64 v5, 4, v1
    s_mul_i32 s50, s52, 12288
    v_lshl_add_u32 v6, v4, 7, s50
    v_lshrrev_b32 v7, 1, v4
    v_xor_b32 v7, v7, v5
    v_xor_b32_e64 v48, 0, v7
    v_lshl_add_u32 v8, v48, 4, v6
    v_add_u32 v10, 79872, v8
    v_xor_b32_e64 v48, 4, v7
    v_lshl_add_u32 v9, v48, 4, v6
    v_add_u32 v11, 79872, v9
    v_bfe_u32 v6, v1, 2, 2
    v_mul_u32_u24 v6, 160, v6
    v_mul_u32_u24 v7, 1920, v5
    v_add_u32_e64 v6, v6, v7
    v_add_u32 v6, 24576, v6
    v_and_b32_e64 v7, 1, v1
    v_bfe_u32 v48, v1, 1, 1
    v_lshl_add_u32 v7, v7, 1, v48
    s_mul_i32 s50, s53, 48
    v_lshl_add_u32 v48, v7, 3, s50
    v_add_u32 v16, v48, v6
    v_cmp_eq_u32 vcc, 3, v7
    v_min_u32 v7, 2, v7
    v_mul_u32_u24 v7, 640, v7
    s_lshl_b32 s50, s53, 3
    s_add_u32 s50, s50, 32
    v_add3_u32 v17, v7, v6, s50
    v_add_u32 v18, 79872, v16
    v_add_u32 v19, 79872, v17
    v_mov_b32 v48, 163584
    v_add_u32 v228, 0, v17
    v_cndmask_b32 v228, v228, v48, vcc
    v_add_u32 v229, 7680, v17
    v_cndmask_b32_e64 v229, v229, v48, vcc
    v_add_u32 v230, 39936, v17
    v_cndmask_b32_e64 v230, v230, v48, vcc
    v_add_u32 v231, 47616, v17
    v_cndmask_b32_e64 v231, v231, v48, vcc
    v_add_u32 v232, 79872, v17
    v_cndmask_b32_e64 v232, v232, v48, vcc
    v_add_u32 v233, 87552, v17
    v_cndmask_b32_e64 v233, v233, v48, vcc
    v_add_u32 v234, 119808, v17
    v_cndmask_b32_e64 v234, v234, v48, vcc
    v_add_u32 v235, 127488, v17
    v_cndmask_b32 v235, v235, v48, vcc
    s_mov_b32 s58, 0
    s_mov_b32 s59, -1
    s_cmp_ge_u32 s6, 20
    s_cbranch_scc1 B_NOREP
    s_waitcnt vmcnt(5)
    buffer_store_dwordx4 v[88:91], v87, s[40:43], s56 offen offset:0
    s_waitcnt vmcnt(5)
    buffer_store_dwordx4 v[92:95], v87, s[40:43], s57 offen offset:0
    s_mov_b32 exec_hi, 0x00ffffff
    s_waitcnt vmcnt(5)
    buffer_store_dwordx4 v[96:99], v87, s[40:43], s56 offen offset:1024
    s_waitcnt vmcnt(5)
    buffer_store_dwordx4 v[100:103], v87, s[40:43], s57 offen offset:1024
B_NOREP:
    s_barrier
    s_waitcnt vmcnt(0)
B_REPD:
    s_mov_b64 exec, 1
    v_mov_b32_e64 v5, 1
    ds_add_rtn_u32 v4, v86, v5
    s_add_u32 s50, s68, s6
    v_mov_b32 v6, s50
    v_mov_b32 v7, s67
    s_waitcnt lgkmcnt(0)
    v_cmp_eq_u32 vcc, 3, v4
    s_cbranch_vccz B_NOSIG
    global_store_byte v6, v7, s[20:21]
B_NOSIG:
    s_mov_b64 exec, -1
    s_cmp_lg_u32 s2, 168
    s_cbranch_scc1 B_NOINIT
    v_mov_b32 v48, 0
    v_mov_b32 v49, 0
    v_mov_b32 v50, 0
    v_mov_b32 v51, 0
    s_mul_i32 s50, s4, 9216
    buffer_store_dwordx4 v[48:51], v87, s[40:43], s50 offen offset:0 sc1
    buffer_store_dwordx4 v[48:51], v87, s[40:43], s50 offen offset:1024 sc1
    buffer_store_dwordx4 v[48:51], v87, s[40:43], s50 offen offset:2048 sc1
    s_add_u32 s50, s50, 3072
    buffer_store_dwordx4 v[48:51], v87, s[40:43], s50 offen offset:0 sc1
    buffer_store_dwordx4 v[48:51], v87, s[40:43], s50 offen offset:1024 sc1
    buffer_store_dwordx4 v[48:51], v87, s[40:43], s50 offen offset:2048 sc1
    s_add_u32 s50, s50, 3072
    buffer_store_dwordx4 v[48:51], v87, s[40:43], s50 offen offset:0 sc1
    buffer_store_dwordx4 v[48:51], v87, s[40:43], s50 offen offset:1024 sc1
    buffer_store_dwordx4 v[48:51], v87, s[40:43], s50 offen offset:2048 sc1
    s_add_u32 s50, s50, 3072
    s_mov_b64 exec, 1
    s_waitcnt vmcnt(0)
    ds_add_rtn_u32 v4, v86, v5 offset:4
    s_waitcnt lgkmcnt(0)
    v_cmp_eq_u32_e64 vcc, 3, v4
    s_cbranch_vccz B_NOINIT
    global_store_dword v48, v5, s[20:21] offset:28 sc1
B_NOINIT:
    s_mov_b64 exec, -1
    s_nop 0
    ds_read_u16 v236, v85 offset:0
    ds_read_u16 v237, v85 offset:40
    ds_read_u16 v238, v85 offset:80
    ds_read_u16 v239, v85 offset:120
    ds_read_u16 v240, v85 offset:320
    ds_read_u16 v241, v85 offset:360
    ds_read_u16 v242, v85 offset:400
    ds_read_u16 v243, v85 offset:440
    ds_read_u16 v244, v84 offset:0
    ds_read_u16 v245, v84 offset:40
    ds_read_u16 v246, v84 offset:80
    ds_read_u16 v247, v84 offset:120
    s_waitcnt lgkmcnt(0)
    s_nop 0
    v_lshl_or_b32 v6, v237, 16, v236
    v_cndmask_b32 v20, 0, v6, s[64:65]
    v_lshl_or_b32 v6, v239, 16, v238
    v_cndmask_b32 v21, 0, v6, s[64:65]
    v_lshl_or_b32 v6, v241, 16, v240
    v_cndmask_b32 v22, 0, v6, s[64:65]
    v_lshl_or_b32 v6, v243, 16, v242
    v_cndmask_b32 v23, 0, v6, s[64:65]
    v_lshl_or_b32 v6, v245, 16, v244
    v_cndmask_b32 v6, 0, v6, s[64:65]
    v_cndmask_b32 v28, 0, v6, s[58:59]
    v_sub_u32 v24, v6, v28
    v_mov_b32 v26, 0
    v_mov_b32_e64 v30, 0
    v_lshl_or_b32 v6, v247, 16, v246
    v_cndmask_b32 v6, 0, v6, s[64:65]
    v_cndmask_b32 v29, 0, v6, s[58:59]
    v_sub_u32 v25, v6, v29
    v_mov_b32 v27, 0
    v_mov_b32_e64 v31, 0
    s_cmp_lg_u32 s4, 1
    s_cbranch_scc1 L_PAGE
    s_mov_b64 exec, 0
    s_branch PG_B0
PG_B_RET:
    s_mov_b64 exec, -1
    s_branch L_PAGE
.p2align 12
L_PAGE:
PG_B0:
    s_cbranch_execz PG_B1
    s_nop 0
    s_barrier
    s_barrier
    ds_read_b64_tr_b16 v[208:209], v16 offset:0
    ds_read_b64_tr_b16 v[210:211], v16 offset:80
    ds_read_b128 v[184:187], v8 offset:0
    ds_read_b64_tr_b16 v[212:213], v16 offset:640
    ds_read_b64_tr_b16 v[214:215], v16 offset:720
    ds_read_b64_tr_b16 v[216:217], v16 offset:1280
    ds_read_b64_tr_b16 v[218:219], v16 offset:1360
    ds_read_b64_tr_b16 v[220:221], v228 offset:0
    ds_read_b64_tr_b16 v[222:223], v228 offset:80
    ds_read_b128 v[188:191], v8 offset:2048
    ds_read_b128 v[192:195], v8 offset:4096
    ds_read_b128 v[196:199], v8 offset:6144
    ds_read_b128 v[200:203], v8 offset:8192
    ds_read_b128 v[204:207], v8 offset:10240
    s_waitcnt lgkmcnt(5)
    s_nop 0
    v_mfma_f32_16x16x32_bf16 v[88:91], v[208:211], v[184:187], 0
    v_mfma_f32_16x16x32_bf16 v[96:99], v[212:215], v[184:187], 0
    ds_read_b64_tr_b16 v[72:73], v16 offset:7680
    v_mfma_f32_16x16x32_bf16 v[104:107], v[216:219], v[184:187], 0
    ds_read_b64_tr_b16 v[74:75], v16 offset:7760
    v_mfma_f32_16x16x32_bf16 v[112:115], v[220:223], v[184:187], 0
    ds_read_b128 v[48:51], v9 offset:0
    s_waitcnt lgkmcnt(6)
    s_nop 0
    v_mfma_f32_16x16x32_bf16 v[92:95], v[208:211], v[188:191], 0
    v_mfma_f32_16x16x32_bf16 v[100:103], v[212:215], v[188:191], 0
    ds_read_b64_tr_b16 v[76:77], v16 offset:8320
    v_mfma_f32_16x16x32_bf16 v[108:111], v[216:219], v[188:191], 0
    ds_read_b64_tr_b16 v[78:79], v16 offset:8400
    v_mfma_f32_16x16x32_bf16 v[116:119], v[220:223], v[188:191], 0
    ds_read_b64_tr_b16 v[80:81], v16 offset:8960
    v_mfma_f32_16x16x32_bf16 v[120:123], v[208:211], v[192:195], 0
    ds_read_b64_tr_b16 v[82:83], v16 offset:9040
    v_mfma_f32_16x16x32_bf16 v[128:131], v[212:215], v[192:195], 0
    ds_read_b64_tr_b16 v[84:85], v229 offset:0
    v_mfma_f32_16x16x32_bf16 v[136:139], v[216:219], v[192:195], 0
    v_mfma_f32_16x16x32_bf16 v[144:147], v[220:223], v[192:195], 0
    ds_read_b64_tr_b16 v[86:87], v229 offset:80
    s_waitcnt lgkmcnt(9)
    s_nop 0
    v_mfma_f32_16x16x32_bf16 v[124:127], v[208:211], v[196:199], 0
    v_mfma_f32_16x16x32_bf16 v[132:135], v[212:215], v[196:199], 0
    ds_read_b128 v[52:55], v9 offset:2048
    v_mfma_f32_16x16x32_bf16 v[140:143], v[216:219], v[196:199], 0
    v_mfma_f32_16x16x32_bf16 v[148:151], v[220:223], v[196:199], 0
    ds_read_b128 v[56:59], v9 offset:4096
    v_mfma_f32_16x16x32_bf16 v[152:155], v[208:211], v[200:203], 0
    v_mfma_f32_16x16x32_bf16 v[160:163], v[212:215], v[200:203], 0
    ds_read_b128 v[60:63], v9 offset:6144
    v_mfma_f32_16x16x32_bf16 v[168:171], v[216:219], v[200:203], 0
    v_mfma_f32_16x16x32_bf16 v[176:179], v[220:223], v[200:203], 0
    ds_read_b128 v[64:67], v9 offset:8192
    v_mfma_f32_16x16x32_bf16 v[156:159], v[208:211], v[204:207], 0
    v_mfma_f32_16x16x32_bf16 v[164:167], v[212:215], v[204:207], 0
    ds_read_b128 v[68:71], v9 offset:10240
    v_mfma_f32_16x16x32_bf16 v[172:175], v[216:219], v[204:207], 0
    v_mfma_f32_16x16x32_bf16 v[180:183], v[220:223], v[204:207], 0
    s_waitcnt lgkmcnt(5)
    v_mfma_f32_16x16x32_bf16 v[88:91], v[72:75], v[48:51], v[88:91]
    s_barrier
    v_mfma_f32_16x16x32_bf16 v[96:99], v[76:79], v[48:51], v[96:99]
    ds_read_b64_tr_b16 v[208:209], v16 offset:39936
    v_mfma_f32_16x16x32_bf16 v[104:107], v[80:83], v[48:51], v[104:107]
    ds_read_b64_tr_b16 v[210:211], v16 offset:40016
    v_mfma_f32_16x16x32_bf16 v[112:115], v[84:87], v[48:51], v[112:115]
    ds_read_b128 v[184:187], v8 offset:39936
    s_waitcnt lgkmcnt(6)
    s_nop 0
    v_mfma_f32_16x16x32_bf16 v[92:95], v[72:75], v[52:55], v[92:95]
    v_mfma_f32_16x16x32_bf16 v[100:103], v[76:79], v[52:55], v[100:103]
    ds_read_b64_tr_b16 v[212:213], v16 offset:40576
    v_mfma_f32_16x16x32_bf16 v[108:111], v[80:83], v[52:55], v[108:111]
    ds_read_b64_tr_b16 v[214:215], v16 offset:40656
    v_mfma_f32_16x16x32_bf16 v[116:119], v[84:87], v[52:55], v[116:119]
    ds_read_b64_tr_b16 v[216:217], v16 offset:41216
    v_mfma_f32_16x16x32_bf16 v[120:123], v[72:75], v[56:59], v[120:123]
    ds_read_b64_tr_b16 v[218:219], v16 offset:41296
    v_mfma_f32_16x16x32_bf16 v[128:131], v[76:79], v[56:59], v[128:131]
    ds_read_b64_tr_b16 v[220:221], v230 offset:0
    v_mfma_f32_16x16x32_bf16 v[136:139], v[80:83], v[56:59], v[136:139]
    v_mfma_f32_16x16x32_bf16 v[144:147], v[84:87], v[56:59], v[144:147]
    ds_read_b64_tr_b16 v[222:223], v230 offset:80
    s_waitcnt lgkmcnt(9)
    s_nop 0
    v_mfma_f32_16x16x32_bf16 v[124:127], v[72:75], v[60:63], v[124:127]
    v_mfma_f32_16x16x32_bf16 v[132:135], v[76:79], v[60:63], v[132:135]
    ds_read_b128 v[188:191], v8 offset:41984
    v_mfma_f32_16x16x32_bf16 v[140:143], v[80:83], v[60:63], v[140:143]
    v_mfma_f32_16x16x32_bf16 v[148:151], v[84:87], v[60:63], v[148:151]
    ds_read_b128 v[192:195], v8 offset:44032
    v_mfma_f32_16x16x32_bf16 v[152:155], v[72:75], v[64:67], v[152:155]
    v_mfma_f32_16x16x32_bf16 v[160:163], v[76:79], v[64:67], v[160:163]
    ds_read_b128 v[196:199], v8 offset:46080
    v_mfma_f32_16x16x32_bf16 v[168:171], v[80:83], v[64:67], v[168:171]
    v_mfma_f32_16x16x32_bf16 v[176:179], v[84:87], v[64:67], v[176:179]
    ds_read_b128 v[200:203], v8 offset:48128
    v_mfma_f32_16x16x32_bf16 v[156:159], v[72:75], v[68:71], v[156:159]
    v_mfma_f32_16x16x32_bf16 v[164:167], v[76:79], v[68:71], v[164:167]
    ds_read_b128 v[204:207], v8 offset:50176
    v_mfma_f32_16x16x32_bf16 v[172:175], v[80:83], v[68:71], v[172:175]
    v_mfma_f32_16x16x32_bf16 v[180:183], v[84:87], v[68:71], v[180:183]
    s_waitcnt lgkmcnt(5)
    s_nop 0
    v_mfma_f32_16x16x32_bf16 v[88:91], v[208:211], v[184:187], v[88:91]
    v_mfma_f32_16x16x32_bf16 v[96:99], v[212:215], v[184:187], v[96:99]
    ds_read_b64_tr_b16 v[72:73], v16 offset:47616
    v_mfma_f32_16x16x32_bf16 v[104:107], v[216:219], v[184:187], v[104:107]
    ds_read_b64_tr_b16 v[74:75], v16 offset:47696
    v_mfma_f32_16x16x32_bf16 v[112:115], v[220:223], v[184:187], v[112:115]
    ds_read_b128 v[48:51], v9 offset:39936
    s_waitcnt lgkmcnt(6)
    s_nop 0
    v_mfma_f32_16x16x32_bf16 v[92:95], v[208:211], v[188:191], v[92:95]
    v_mfma_f32_16x16x32_bf16 v[100:103], v[212:215], v[188:191], v[100:103]
    ds_read_b64_tr_b16 v[76:77], v16 offset:48256
    v_mfma_f32_16x16x32_bf16 v[108:111], v[216:219], v[188:191], v[108:111]
    ds_read_b64_tr_b16 v[78:79], v16 offset:48336
    v_mfma_f32_16x16x32_bf16 v[116:119], v[220:223], v[188:191], v[116:119]
    ds_read_b64_tr_b16 v[80:81], v16 offset:48896
    v_mfma_f32_16x16x32_bf16 v[120:123], v[208:211], v[192:195], v[120:123]
    ds_read_b64_tr_b16 v[82:83], v16 offset:48976
    v_mfma_f32_16x16x32_bf16 v[128:131], v[212:215], v[192:195], v[128:131]
    ds_read_b64_tr_b16 v[84:85], v231 offset:0
    v_mfma_f32_16x16x32_bf16 v[136:139], v[216:219], v[192:195], v[136:139]
    v_mfma_f32_16x16x32_bf16 v[144:147], v[220:223], v[192:195], v[144:147]
    ds_read_b64_tr_b16 v[86:87], v231 offset:80
    s_waitcnt lgkmcnt(9)
    s_nop 0
    v_mfma_f32_16x16x32_bf16 v[124:127], v[208:211], v[196:199], v[124:127]
    v_mfma_f32_16x16x32_bf16 v[132:135], v[212:215], v[196:199], v[132:135]
    ds_read_b128 v[52:55], v9 offset:41984
    v_mfma_f32_16x16x32_bf16 v[140:143], v[216:219], v[196:199], v[140:143]
    v_mfma_f32_16x16x32_bf16 v[148:151], v[220:223], v[196:199], v[148:151]
    ds_read_b128 v[56:59], v9 offset:44032
    v_mfma_f32_16x16x32_bf16 v[152:155], v[208:211], v[200:203], v[152:155]
    v_mfma_f32_16x16x32_bf16 v[160:163], v[212:215], v[200:203], v[160:163]
    ds_read_b128 v[60:63], v9 offset:46080
    v_mfma_f32_16x16x32_bf16 v[168:171], v[216:219], v[200:203], v[168:171]
    v_mfma_f32_16x16x32_bf16 v[176:179], v[220:223], v[200:203], v[176:179]
    ds_read_b128 v[64:67], v9 offset:48128
    v_mfma_f32_16x16x32_bf16 v[156:159], v[208:211], v[204:207], v[156:159]
    v_mfma_f32_16x16x32_bf16 v[164:167], v[212:215], v[204:207], v[164:167]
    ds_read_b128 v[68:71], v9 offset:50176
    v_mfma_f32_16x16x32_bf16 v[172:175], v[216:219], v[204:207], v[172:175]
    v_mfma_f32_16x16x32_bf16 v[180:183], v[220:223], v[204:207], v[180:183]
    s_waitcnt lgkmcnt(5)
    v_mfma_f32_16x16x32_bf16 v[88:91], v[72:75], v[48:51], v[88:91]
    s_barrier
    v_mfma_f32_16x16x32_bf16 v[96:99], v[76:79], v[48:51], v[96:99]
    ds_read_b64_tr_b16 v[208:209], v18 offset:0
    v_mfma_f32_16x16x32_bf16 v[104:107], v[80:83], v[48:51], v[104:107]
    ds_read_b64_tr_b16 v[210:211], v18 offset:80
    v_mfma_f32_16x16x32_bf16 v[112:115], v[84:87], v[48:51], v[112:115]
    ds_read_b128 v[184:187], v10 offset:0
    s_waitcnt lgkmcnt(6)
    s_nop 0
    v_mfma_f32_16x16x32_bf16 v[92:95], v[72:75], v[52:55], v[92:95]
    v_mfma_f32_16x16x32_bf16 v[100:103], v[76:79], v[52:55], v[100:103]
    ds_read_b64_tr_b16 v[212:213], v18 offset:640
    v_mfma_f32_16x16x32_bf16 v[108:111], v[80:83], v[52:55], v[108:111]
    ds_read_b64_tr_b16 v[214:215], v18 offset:720
    v_mfma_f32_16x16x32_bf16 v[116:119], v[84:87], v[52:55], v[116:119]
    ds_read_b64_tr_b16 v[216:217], v18 offset:1280
    v_mfma_f32_16x16x32_bf16 v[120:123], v[72:75], v[56:59], v[120:123]
    ds_read_b64_tr_b16 v[218:219], v18 offset:1360
    v_mfma_f32_16x16x32_bf16 v[128:131], v[76:79], v[56:59], v[128:131]
    ds_read_b64_tr_b16 v[220:221], v232 offset:0
    v_mfma_f32_16x16x32_bf16 v[136:139], v[80:83], v[56:59], v[136:139]
    v_mfma_f32_16x16x32_bf16 v[144:147], v[84:87], v[56:59], v[144:147]
    ds_read_b64_tr_b16 v[222:223], v232 offset:80
    s_waitcnt lgkmcnt(9)
    s_nop 0
    v_mfma_f32_16x16x32_bf16 v[124:127], v[72:75], v[60:63], v[124:127]
    v_mfma_f32_16x16x32_bf16 v[132:135], v[76:79], v[60:63], v[132:135]
    ds_read_b128 v[188:191], v10 offset:2048
    v_mfma_f32_16x16x32_bf16 v[140:143], v[80:83], v[60:63], v[140:143]
    v_mfma_f32_16x16x32_bf16 v[148:151], v[84:87], v[60:63], v[148:151]
    ds_read_b128 v[192:195], v10 offset:4096
    v_mfma_f32_16x16x32_bf16 v[152:155], v[72:75], v[64:67], v[152:155]
    v_mfma_f32_16x16x32_bf16 v[160:163], v[76:79], v[64:67], v[160:163]
    ds_read_b128 v[196:199], v10 offset:6144
    v_mfma_f32_16x16x32_bf16 v[168:171], v[80:83], v[64:67], v[168:171]
    v_mfma_f32_16x16x32_bf16 v[176:179], v[84:87], v[64:67], v[176:179]
    ds_read_b128 v[200:203], v10 offset:8192
    v_mfma_f32_16x16x32_bf16 v[156:159], v[72:75], v[68:71], v[156:159]
    v_mfma_f32_16x16x32_bf16 v[164:167], v[76:79], v[68:71], v[164:167]
    ds_read_b128 v[204:207], v10 offset:10240
    v_mfma_f32_16x16x32_bf16 v[172:175], v[80:83], v[68:71], v[172:175]
    v_mfma_f32_16x16x32_bf16 v[180:183], v[84:87], v[68:71], v[180:183]
    s_waitcnt lgkmcnt(5)
    s_nop 0
    v_mfma_f32_16x16x32_bf16 v[88:91], v[208:211], v[184:187], v[88:91]
    v_mfma_f32_16x16x32_bf16 v[96:99], v[212:215], v[184:187], v[96:99]
    ds_read_b64_tr_b16 v[72:73], v18 offset:7680
    v_mfma_f32_16x16x32_bf16 v[104:107], v[216:219], v[184:187], v[104:107]
    ds_read_b64_tr_b16 v[74:75], v18 offset:7760
    v_mfma_f32_16x16x32_bf16 v[112:115], v[220:223], v[184:187], v[112:115]
    ds_read_b128 v[48:51], v11 offset:0
    s_waitcnt lgkmcnt(6)
    s_nop 0
    v_mfma_f32_16x16x32_bf16 v[92:95], v[208:211], v[188:191], v[92:95]
    v_mfma_f32_16x16x32_bf16 v[100:103], v[212:215], v[188:191], v[100:103]
    ds_read_b64_tr_b16 v[76:77], v18 offset:8320
    v_mfma_f32_16x16x32_bf16 v[108:111], v[216:219], v[188:191], v[108:111]
    ds_read_b64_tr_b16 v[78:79], v18 offset:8400
    v_mfma_f32_16x16x32_bf16 v[116:119], v[220:223], v[188:191], v[116:119]
    ds_read_b64_tr_b16 v[80:81], v18 offset:8960
    v_mfma_f32_16x16x32_bf16 v[120:123], v[208:211], v[192:195], v[120:123]
    ds_read_b64_tr_b16 v[82:83], v18 offset:9040
    v_mfma_f32_16x16x32_bf16 v[128:131], v[212:215], v[192:195], v[128:131]
    ds_read_b64_tr_b16 v[84:85], v233 offset:0
    v_mfma_f32_16x16x32_bf16 v[136:139], v[216:219], v[192:195], v[136:139]
    v_mfma_f32_16x16x32_bf16 v[144:147], v[220:223], v[192:195], v[144:147]
    ds_read_b64_tr_b16 v[86:87], v233 offset:80
    s_waitcnt lgkmcnt(9)
    s_nop 0
    v_mfma_f32_16x16x32_bf16 v[124:127], v[208:211], v[196:199], v[124:127]
    v_mfma_f32_16x16x32_bf16 v[132:135], v[212:215], v[196:199], v[132:135]
    ds_read_b128 v[52:55], v11 offset:2048
    v_mfma_f32_16x16x32_bf16 v[140:143], v[216:219], v[196:199], v[140:143]
    v_mfma_f32_16x16x32_bf16 v[148:151], v[220:223], v[196:199], v[148:151]
    ds_read_b128 v[56:59], v11 offset:4096
    v_mfma_f32_16x16x32_bf16 v[152:155], v[208:211], v[200:203], v[152:155]
    v_mfma_f32_16x16x32_bf16 v[160:163], v[212:215], v[200:203], v[160:163]
    ds_read_b128 v[60:63], v11 offset:6144
    v_mfma_f32_16x16x32_bf16 v[168:171], v[216:219], v[200:203], v[168:171]
    v_mfma_f32_16x16x32_bf16 v[176:179], v[220:223], v[200:203], v[176:179]
    ds_read_b128 v[64:67], v11 offset:8192
    v_mfma_f32_16x16x32_bf16 v[156:159], v[208:211], v[204:207], v[156:159]
    v_mfma_f32_16x16x32_bf16 v[164:167], v[212:215], v[204:207], v[164:167]
    ds_read_b128 v[68:71], v11 offset:10240
    v_mfma_f32_16x16x32_bf16 v[172:175], v[216:219], v[204:207], v[172:175]
    v_mfma_f32_16x16x32_bf16 v[180:183], v[220:223], v[204:207], v[180:183]
    s_waitcnt lgkmcnt(5)
    v_mfma_f32_16x16x32_bf16 v[88:91], v[72:75], v[48:51], v[88:91]
    s_barrier
    v_mfma_f32_16x16x32_bf16 v[96:99], v[76:79], v[48:51], v[96:99]
    ds_read_b64_tr_b16 v[208:209], v18 offset:39936
    v_mfma_f32_16x16x32_bf16 v[104:107], v[80:83], v[48:51], v[104:107]
    ds_read_b64_tr_b16 v[210:211], v18 offset:40016
    v_mfma_f32_16x16x32_bf16 v[112:115], v[84:87], v[48:51], v[112:115]
    ds_read_b128 v[184:187], v10 offset:39936
    s_waitcnt lgkmcnt(6)
    s_nop 0
    v_mfma_f32_16x16x32_bf16 v[92:95], v[72:75], v[52:55], v[92:95]
    v_mfma_f32_16x16x32_bf16 v[100:103], v[76:79], v[52:55], v[100:103]
    ds_read_b64_tr_b16 v[212:213], v18 offset:40576
    v_mfma_f32_16x16x32_bf16 v[108:111], v[80:83], v[52:55], v[108:111]
    ds_read_b64_tr_b16 v[214:215], v18 offset:40656
    v_mfma_f32_16x16x32_bf16 v[116:119], v[84:87], v[52:55], v[116:119]
    ds_read_b64_tr_b16 v[216:217], v18 offset:41216
    v_mfma_f32_16x16x32_bf16 v[120:123], v[72:75], v[56:59], v[120:123]
    ds_read_b64_tr_b16 v[218:219], v18 offset:41296
    v_mfma_f32_16x16x32_bf16 v[128:131], v[76:79], v[56:59], v[128:131]
    ds_read_b64_tr_b16 v[220:221], v234 offset:0
    v_mfma_f32_16x16x32_bf16 v[136:139], v[80:83], v[56:59], v[136:139]
    v_mfma_f32_16x16x32_bf16 v[144:147], v[84:87], v[56:59], v[144:147]
    ds_read_b64_tr_b16 v[222:223], v234 offset:80
    s_waitcnt lgkmcnt(9)
    s_nop 0
    v_mfma_f32_16x16x32_bf16 v[124:127], v[72:75], v[60:63], v[124:127]
    v_mfma_f32_16x16x32_bf16 v[132:135], v[76:79], v[60:63], v[132:135]
    ds_read_b128 v[188:191], v10 offset:41984
    v_mfma_f32_16x16x32_bf16 v[140:143], v[80:83], v[60:63], v[140:143]
    v_mfma_f32_16x16x32_bf16 v[148:151], v[84:87], v[60:63], v[148:151]
    ds_read_b128 v[192:195], v10 offset:44032
    v_mfma_f32_16x16x32_bf16 v[152:155], v[72:75], v[64:67], v[152:155]
    v_mfma_f32_16x16x32_bf16 v[160:163], v[76:79], v[64:67], v[160:163]
    ds_read_b128 v[196:199], v10 offset:46080
    v_mfma_f32_16x16x32_bf16 v[168:171], v[80:83], v[64:67], v[168:171]
    v_mfma_f32_16x16x32_bf16 v[176:179], v[84:87], v[64:67], v[176:179]
    ds_read_b128 v[200:203], v10 offset:48128
    v_mfma_f32_16x16x32_bf16 v[156:159], v[72:75], v[68:71], v[156:159]
    v_mfma_f32_16x16x32_bf16 v[164:167], v[76:79], v[68:71], v[164:167]
    ds_read_b128 v[204:207], v10 offset:50176
    v_mfma_f32_16x16x32_bf16 v[172:175], v[80:83], v[68:71], v[172:175]
    v_mfma_f32_16x16x32_bf16 v[180:183], v[84:87], v[68:71], v[180:183]
    s_waitcnt lgkmcnt(5)
    s_nop 0
    v_mfma_f32_16x16x32_bf16 v[88:91], v[208:211], v[184:187], v[88:91]
    v_mfma_f32_16x16x32_bf16 v[96:99], v[212:215], v[184:187], v[96:99]
    ds_read_b64_tr_b16 v[72:73], v18 offset:47616
    v_mfma_f32_16x16x32_bf16 v[104:107], v[216:219], v[184:187], v[104:107]
    ds_read_b64_tr_b16 v[74:75], v18 offset:47696
    v_mfma_f32_16x16x32_bf16 v[112:115], v[220:223], v[184:187], v[112:115]
    ds_read_b128 v[48:51], v11 offset:39936
    s_waitcnt lgkmcnt(6)
    s_nop 0
    v_mfma_f32_16x16x32_bf16 v[92:95], v[208:211], v[188:191], v[92:95]
    v_mfma_f32_16x16x32_bf16 v[100:103], v[212:215], v[188:191], v[100:103]
    ds_read_b64_tr_b16 v[76:77], v18 offset:48256
    v_mfma_f32_16x16x32_bf16 v[108:111], v[216:219], v[188:191], v[108:111]
    ds_read_b64_tr_b16 v[78:79], v18 offset:48336
    v_mfma_f32_16x16x32_bf16 v[116:119], v[220:223], v[188:191], v[116:119]
    ds_read_b64_tr_b16 v[80:81], v18 offset:48896
    v_mfma_f32_16x16x32_bf16 v[120:123], v[208:211], v[192:195], v[120:123]
    ds_read_b64_tr_b16 v[82:83], v18 offset:48976
    v_mfma_f32_16x16x32_bf16 v[128:131], v[212:215], v[192:195], v[128:131]
    ds_read_b64_tr_b16 v[84:85], v235 offset:0
    v_mfma_f32_16x16x32_bf16 v[136:139], v[216:219], v[192:195], v[136:139]
    v_mfma_f32_16x16x32_bf16 v[144:147], v[220:223], v[192:195], v[144:147]
    ds_read_b64_tr_b16 v[86:87], v235 offset:80
    s_waitcnt lgkmcnt(9)
    s_nop 0
    v_mfma_f32_16x16x32_bf16 v[124:127], v[208:211], v[196:199], v[124:127]
    v_mfma_f32_16x16x32_bf16 v[132:135], v[212:215], v[196:199], v[132:135]
    ds_read_b128 v[52:55], v11 offset:41984
    v_mfma_f32_16x16x32_bf16 v[140:143], v[216:219], v[196:199], v[140:143]
    v_mfma_f32_16x16x32_bf16 v[148:151], v[220:223], v[196:199], v[148:151]
    ds_read_b128 v[56:59], v11 offset:44032
    v_mfma_f32_16x16x32_bf16 v[152:155], v[208:211], v[200:203], v[152:155]
    v_mfma_f32_16x16x32_bf16 v[160:163], v[212:215], v[200:203], v[160:163]
    ds_read_b128 v[60:63], v11 offset:46080
    v_mfma_f32_16x16x32_bf16 v[168:171], v[216:219], v[200:203], v[168:171]
    v_mfma_f32_16x16x32_bf16 v[176:179], v[220:223], v[200:203], v[176:179]
    ds_read_b128 v[64:67], v11 offset:48128
    v_mfma_f32_16x16x32_bf16 v[156:159], v[208:211], v[204:207], v[156:159]
    v_mfma_f32_16x16x32_bf16 v[164:167], v[212:215], v[204:207], v[164:167]
    ds_read_b128 v[68:71], v11 offset:50176
    v_mfma_f32_16x16x32_bf16 v[172:175], v[216:219], v[204:207], v[172:175]
    v_mfma_f32_16x16x32_bf16 v[180:183], v[220:223], v[204:207], v[180:183]
    s_waitcnt lgkmcnt(5)
    v_mfma_f32_16x16x32_bf16 v[88:91], v[72:75], v[48:51], v[88:91]
    s_barrier
    v_mfma_f32_16x16x32_bf16 v[96:99], v[76:79], v[48:51], v[96:99]
    ds_read_b64_tr_b16 v[208:209], v16 offset:0
    v_mfma_f32_16x16x32_bf16 v[104:107], v[80:83], v[48:51], v[104:107]
    ds_read_b64_tr_b16 v[210:211], v16 offset:80
    v_mfma_f32_16x16x32_bf16 v[112:115], v[84:87], v[48:51], v[112:115]
    ds_read_b128 v[184:187], v8 offset:0
    s_waitcnt lgkmcnt(6)
    s_nop 0
    v_mfma_f32_16x16x32_bf16 v[92:95], v[72:75], v[52:55], v[92:95]
    v_mfma_f32_16x16x32_bf16 v[100:103], v[76:79], v[52:55], v[100:103]
    ds_read_b64_tr_b16 v[212:213], v16 offset:640
    v_mfma_f32_16x16x32_bf16 v[108:111], v[80:83], v[52:55], v[108:111]
    ds_read_b64_tr_b16 v[214:215], v16 offset:720
    v_mfma_f32_16x16x32_bf16 v[116:119], v[84:87], v[52:55], v[116:119]
    ds_read_b64_tr_b16 v[216:217], v16 offset:1280
    v_mfma_f32_16x16x32_bf16 v[120:123], v[72:75], v[56:59], v[120:123]
    ds_read_b64_tr_b16 v[218:219], v16 offset:1360
    v_mfma_f32_16x16x32_bf16 v[128:131], v[76:79], v[56:59], v[128:131]
    ds_read_b64_tr_b16 v[220:221], v228 offset:0
    v_mfma_f32_16x16x32_bf16 v[136:139], v[80:83], v[56:59], v[136:139]
    v_mfma_f32_16x16x32_bf16 v[144:147], v[84:87], v[56:59], v[144:147]
    ds_read_b64_tr_b16 v[222:223], v228 offset:80
    s_waitcnt lgkmcnt(9)
    s_nop 0
    v_mfma_f32_16x16x32_bf16 v[124:127], v[72:75], v[60:63], v[124:127]
    v_mfma_f32_16x16x32_bf16 v[132:135], v[76:79], v[60:63], v[132:135]
    ds_read_b128 v[188:191], v8 offset:2048
    v_mfma_f32_16x16x32_bf16 v[140:143], v[80:83], v[60:63], v[140:143]
    v_mfma_f32_16x16x32_bf16 v[148:151], v[84:87], v[60:63], v[148:151]
    ds_read_b128 v[192:195], v8 offset:4096
    v_mfma_f32_16x16x32_bf16 v[152:155], v[72:75], v[64:67], v[152:155]
    v_mfma_f32_16x16x32_bf16 v[160:163], v[76:79], v[64:67], v[160:163]
    ds_read_b128 v[196:199], v8 offset:6144
    v_mfma_f32_16x16x32_bf16 v[168:171], v[80:83], v[64:67], v[168:171]
    v_mfma_f32_16x16x32_bf16 v[176:179], v[84:87], v[64:67], v[176:179]
    ds_read_b128 v[200:203], v8 offset:8192
    v_mfma_f32_16x16x32_bf16 v[156:159], v[72:75], v[68:71], v[156:159]
    v_mfma_f32_16x16x32_bf16 v[164:167], v[76:79], v[68:71], v[164:167]
    ds_read_b128 v[204:207], v8 offset:10240
    v_mfma_f32_16x16x32_bf16 v[172:175], v[80:83], v[68:71], v[172:175]
    v_mfma_f32_16x16x32_bf16 v[180:183], v[84:87], v[68:71], v[180:183]
    s_waitcnt lgkmcnt(5)
    s_nop 0
    v_mfma_f32_16x16x32_bf16 v[88:91], v[208:211], v[184:187], v[88:91]
    v_mfma_f32_16x16x32_bf16 v[96:99], v[212:215], v[184:187], v[96:99]
    ds_read_b64_tr_b16 v[72:73], v16 offset:7680
    v_mfma_f32_16x16x32_bf16 v[104:107], v[216:219], v[184:187], v[104:107]
    ds_read_b64_tr_b16 v[74:75], v16 offset:7760
    v_mfma_f32_16x16x32_bf16 v[112:115], v[220:223], v[184:187], v[112:115]
    ds_read_b128 v[48:51], v9 offset:0
    s_waitcnt lgkmcnt(6)
    s_nop 0
    v_mfma_f32_16x16x32_bf16 v[92:95], v[208:211], v[188:191], v[92:95]
    v_mfma_f32_16x16x32_bf16 v[100:103], v[212:215], v[188:191], v[100:103]
    ds_read_b64_tr_b16 v[76:77], v16 offset:8320
    v_mfma_f32_16x16x32_bf16 v[108:111], v[216:219], v[188:191], v[108:111]
    ds_read_b64_tr_b16 v[78:79], v16 offset:8400
    v_mfma_f32_16x16x32_bf16 v[116:119], v[220:223], v[188:191], v[116:119]
    ds_read_b64_tr_b16 v[80:81], v16 offset:8960
    v_mfma_f32_16x16x32_bf16 v[120:123], v[208:211], v[192:195], v[120:123]
    ds_read_b64_tr_b16 v[82:83], v16 offset:9040
    v_mfma_f32_16x16x32_bf16 v[128:131], v[212:215], v[192:195], v[128:131]
    ds_read_b64_tr_b16 v[84:85], v229 offset:0
    v_mfma_f32_16x16x32_bf16 v[136:139], v[216:219], v[192:195], v[136:139]
    v_mfma_f32_16x16x32_bf16 v[144:147], v[220:223], v[192:195], v[144:147]
    ds_read_b64_tr_b16 v[86:87], v229 offset:80
    s_waitcnt lgkmcnt(9)
    s_nop 0
    v_mfma_f32_16x16x32_bf16 v[124:127], v[208:211], v[196:199], v[124:127]
    v_mfma_f32_16x16x32_bf16 v[132:135], v[212:215], v[196:199], v[132:135]
    ds_read_b128 v[52:55], v9 offset:2048
    v_mfma_f32_16x16x32_bf16 v[140:143], v[216:219], v[196:199], v[140:143]
    v_mfma_f32_16x16x32_bf16 v[148:151], v[220:223], v[196:199], v[148:151]
    ds_read_b128 v[56:59], v9 offset:4096
    v_mfma_f32_16x16x32_bf16 v[152:155], v[208:211], v[200:203], v[152:155]
    v_mfma_f32_16x16x32_bf16 v[160:163], v[212:215], v[200:203], v[160:163]
    ds_read_b128 v[60:63], v9 offset:6144
    v_mfma_f32_16x16x32_bf16 v[168:171], v[216:219], v[200:203], v[168:171]
    v_mfma_f32_16x16x32_bf16 v[176:179], v[220:223], v[200:203], v[176:179]
    ds_read_b128 v[64:67], v9 offset:8192
    v_mfma_f32_16x16x32_bf16 v[156:159], v[208:211], v[204:207], v[156:159]
    v_mfma_f32_16x16x32_bf16 v[164:167], v[212:215], v[204:207], v[164:167]
    ds_read_b128 v[68:71], v9 offset:10240
    v_mfma_f32_16x16x32_bf16 v[172:175], v[216:219], v[204:207], v[172:175]
    v_mfma_f32_16x16x32_bf16 v[180:183], v[220:223], v[204:207], v[180:183]
    s_waitcnt lgkmcnt(5)
    v_mfma_f32_16x16x32_bf16 v[88:91], v[72:75], v[48:51], v[88:91]
    s_barrier
    v_mfma_f32_16x16x32_bf16 v[96:99], v[76:79], v[48:51], v[96:99]
    ds_read_b64_tr_b16 v[208:209], v16 offset:39936
    v_mfma_f32_16x16x32_bf16 v[104:107], v[80:83], v[48:51], v[104:107]
    ds_read_b64_tr_b16 v[210:211], v16 offset:40016
    v_mfma_f32_16x16x32_bf16 v[112:115], v[84:87], v[48:51], v[112:115]
    ds_read_b128 v[184:187], v8 offset:39936
    s_waitcnt lgkmcnt(6)
    s_nop 0
    v_mfma_f32_16x16x32_bf16 v[92:95], v[72:75], v[52:55], v[92:95]
    v_mfma_f32_16x16x32_bf16 v[100:103], v[76:79], v[52:55], v[100:103]
    ds_read_b64_tr_b16 v[212:213], v16 offset:40576
    v_mfma_f32_16x16x32_bf16 v[108:111], v[80:83], v[52:55], v[108:111]
    ds_read_b64_tr_b16 v[214:215], v16 offset:40656
    v_mfma_f32_16x16x32_bf16 v[116:119], v[84:87], v[52:55], v[116:119]
    ds_read_b64_tr_b16 v[216:217], v16 offset:41216
    v_mfma_f32_16x16x32_bf16 v[120:123], v[72:75], v[56:59], v[120:123]
    ds_read_b64_tr_b16 v[218:219], v16 offset:41296
    v_mfma_f32_16x16x32_bf16 v[128:131], v[76:79], v[56:59], v[128:131]
    ds_read_b64_tr_b16 v[220:221], v230 offset:0
    v_mfma_f32_16x16x32_bf16 v[136:139], v[80:83], v[56:59], v[136:139]
    v_mfma_f32_16x16x32_bf16 v[144:147], v[84:87], v[56:59], v[144:147]
    ds_read_b64_tr_b16 v[222:223], v230 offset:80
    s_waitcnt lgkmcnt(9)
    s_nop 0
    v_mfma_f32_16x16x32_bf16 v[124:127], v[72:75], v[60:63], v[124:127]
    v_mfma_f32_16x16x32_bf16 v[132:135], v[76:79], v[60:63], v[132:135]
    ds_read_b128 v[188:191], v8 offset:41984
    v_mfma_f32_16x16x32_bf16 v[140:143], v[80:83], v[60:63], v[140:143]
    v_mfma_f32_16x16x32_bf16 v[148:151], v[84:87], v[60:63], v[148:151]
    ds_read_b128 v[192:195], v8 offset:44032
    v_mfma_f32_16x16x32_bf16 v[152:155], v[72:75], v[64:67], v[152:155]
    v_mfma_f32_16x16x32_bf16 v[160:163], v[76:79], v[64:67], v[160:163]
    ds_read_b128 v[196:199], v8 offset:46080
    v_mfma_f32_16x16x32_bf16 v[168:171], v[80:83], v[64:67], v[168:171]
    v_mfma_f32_16x16x32_bf16 v[176:179], v[84:87], v[64:67], v[176:179]
    ds_read_b128 v[200:203], v8 offset:48128
    v_mfma_f32_16x16x32_bf16 v[156:159], v[72:75], v[68:71], v[156:159]
    v_mfma_f32_16x16x32_bf16 v[164:167], v[76:79], v[68:71], v[164:167]
    ds_read_b128 v[204:207], v8 offset:50176
    v_mfma_f32_16x16x32_bf16 v[172:175], v[80:83], v[68:71], v[172:175]
    v_mfma_f32_16x16x32_bf16 v[180:183], v[84:87], v[68:71], v[180:183]
    s_waitcnt lgkmcnt(5)
    s_nop 0
    v_mfma_f32_16x16x32_bf16 v[88:91], v[208:211], v[184:187], v[88:91]
    v_mfma_f32_16x16x32_bf16 v[96:99], v[212:215], v[184:187], v[96:99]
    ds_read_b64_tr_b16 v[72:73], v16 offset:47616
    v_mfma_f32_16x16x32_bf16 v[104:107], v[216:219], v[184:187], v[104:107]
    ds_read_b64_tr_b16 v[74:75], v16 offset:47696
    v_mfma_f32_16x16x32_bf16 v[112:115], v[220:223], v[184:187], v[112:115]
    ds_read_b128 v[48:51], v9 offset:39936
    s_waitcnt lgkmcnt(6)
    s_nop 0
    v_mfma_f32_16x16x32_bf16 v[92:95], v[208:211], v[188:191], v[92:95]
    v_mfma_f32_16x16x32_bf16 v[100:103], v[212:215], v[188:191], v[100:103]
    ds_read_b64_tr_b16 v[76:77], v16 offset:48256
    v_mfma_f32_16x16x32_bf16 v[108:111], v[216:219], v[188:191], v[108:111]
    ds_read_b64_tr_b16 v[78:79], v16 offset:48336
    v_mfma_f32_16x16x32_bf16 v[116:119], v[220:223], v[188:191], v[116:119]
    ds_read_b64_tr_b16 v[80:81], v16 offset:48896
    v_mfma_f32_16x16x32_bf16 v[120:123], v[208:211], v[192:195], v[120:123]
    ds_read_b64_tr_b16 v[82:83], v16 offset:48976
    v_mfma_f32_16x16x32_bf16 v[128:131], v[212:215], v[192:195], v[128:131]
    ds_read_b64_tr_b16 v[84:85], v231 offset:0
    v_mfma_f32_16x16x32_bf16 v[136:139], v[216:219], v[192:195], v[136:139]
    v_mfma_f32_16x16x32_bf16 v[144:147], v[220:223], v[192:195], v[144:147]
    ds_read_b64_tr_b16 v[86:87], v231 offset:80
    s_waitcnt lgkmcnt(9)
    s_nop 0
    v_mfma_f32_16x16x32_bf16 v[124:127], v[208:211], v[196:199], v[124:127]
    v_mfma_f32_16x16x32_bf16 v[132:135], v[212:215], v[196:199], v[132:135]
    ds_read_b128 v[52:55], v9 offset:41984
    v_mfma_f32_16x16x32_bf16 v[140:143], v[216:219], v[196:199], v[140:143]
    v_mfma_f32_16x16x32_bf16 v[148:151], v[220:223], v[196:199], v[148:151]
    ds_read_b128 v[56:59], v9 offset:44032
    v_mfma_f32_16x16x32_bf16 v[152:155], v[208:211], v[200:203], v[152:155]
    v_mfma_f32_16x16x32_bf16 v[160:163], v[212:215], v[200:203], v[160:163]
    ds_read_b128 v[60:63], v9 offset:46080
    v_mfma_f32_16x16x32_bf16 v[168:171], v[216:219], v[200:203], v[168:171]
    v_mfma_f32_16x16x32_bf16 v[176:179], v[220:223], v[200:203], v[176:179]
    ds_read_b128 v[64:67], v9 offset:48128
    v_mfma_f32_16x16x32_bf16 v[156:159], v[208:211], v[204:207], v[156:159]
    v_mfma_f32_16x16x32_bf16 v[164:167], v[212:215], v[204:207], v[164:167]
    ds_read_b128 v[68:71], v9 offset:50176
    v_mfma_f32_16x16x32_bf16 v[172:175], v[216:219], v[204:207], v[172:175]
    v_mfma_f32_16x16x32_bf16 v[180:183], v[220:223], v[204:207], v[180:183]
    s_waitcnt lgkmcnt(5)
    v_mfma_f32_16x16x32_bf16 v[88:91], v[72:75], v[48:51], v[88:91]
    s_barrier
    v_mfma_f32_16x16x32_bf16 v[96:99], v[76:79], v[48:51], v[96:99]
    ds_read_b64_tr_b16 v[208:209], v18 offset:0
    v_mfma_f32_16x16x32_bf16 v[104:107], v[80:83], v[48:51], v[104:107]
    ds_read_b64_tr_b16 v[210:211], v18 offset:80
    v_mfma_f32_16x16x32_bf16 v[112:115], v[84:87], v[48:51], v[112:115]
    ds_read_b128 v[184:187], v10 offset:0
    s_waitcnt lgkmcnt(6)
    s_nop 0
    v_mfma_f32_16x16x32_bf16 v[92:95], v[72:75], v[52:55], v[92:95]
    v_mfma_f32_16x16x32_bf16 v[100:103], v[76:79], v[52:55], v[100:103]
    ds_read_b64_tr_b16 v[212:213], v18 offset:640
    v_mfma_f32_16x16x32_bf16 v[108:111], v[80:83], v[52:55], v[108:111]
    ds_read_b64_tr_b16 v[214:215], v18 offset:720
    v_mfma_f32_16x16x32_bf16 v[116:119], v[84:87], v[52:55], v[116:119]
    ds_read_b64_tr_b16 v[216:217], v18 offset:1280
    v_mfma_f32_16x16x32_bf16 v[120:123], v[72:75], v[56:59], v[120:123]
    ds_read_b64_tr_b16 v[218:219], v18 offset:1360
    v_mfma_f32_16x16x32_bf16 v[128:131], v[76:79], v[56:59], v[128:131]
    ds_read_b64_tr_b16 v[220:221], v232 offset:0
    v_mfma_f32_16x16x32_bf16 v[136:139], v[80:83], v[56:59], v[136:139]
    v_mfma_f32_16x16x32_bf16 v[144:147], v[84:87], v[56:59], v[144:147]
    ds_read_b64_tr_b16 v[222:223], v232 offset:80
    s_waitcnt lgkmcnt(9)
    s_nop 0
    v_mfma_f32_16x16x32_bf16 v[124:127], v[72:75], v[60:63], v[124:127]
    v_mfma_f32_16x16x32_bf16 v[132:135], v[76:79], v[60:63], v[132:135]
    ds_read_b128 v[188:191], v10 offset:2048
    v_mfma_f32_16x16x32_bf16 v[140:143], v[80:83], v[60:63], v[140:143]
    v_mfma_f32_16x16x32_bf16 v[148:151], v[84:87], v[60:63], v[148:151]
    ds_read_b128 v[192:195], v10 offset:4096
    v_mfma_f32_16x16x32_bf16 v[152:155], v[72:75], v[64:67], v[152:155]
    v_mfma_f32_16x16x32_bf16 v[160:163], v[76:79], v[64:67], v[160:163]
    ds_read_b128 v[196:199], v10 offset:6144
    v_mfma_f32_16x16x32_bf16 v[168:171], v[80:83], v[64:67], v[168:171]
    v_mfma_f32_16x16x32_bf16 v[176:179], v[84:87], v[64:67], v[176:179]
    ds_read_b128 v[200:203], v10 offset:8192
    v_mfma_f32_16x16x32_bf16 v[156:159], v[72:75], v[68:71], v[156:159]
    v_mfma_f32_16x16x32_bf16 v[164:167], v[76:79], v[68:71], v[164:167]
    ds_read_b128 v[204:207], v10 offset:10240
    v_mfma_f32_16x16x32_bf16 v[172:175], v[80:83], v[68:71], v[172:175]
    v_mfma_f32_16x16x32_bf16 v[180:183], v[84:87], v[68:71], v[180:183]
    s_waitcnt lgkmcnt(5)
    s_nop 0
    v_mfma_f32_16x16x32_bf16 v[88:91], v[208:211], v[184:187], v[88:91]
    v_mfma_f32_16x16x32_bf16 v[96:99], v[212:215], v[184:187], v[96:99]
    ds_read_b64_tr_b16 v[72:73], v18 offset:7680
PG_B1:
    s_cbranch_execz PG_B2
    s_nop 0
    v_mfma_f32_16x16x32_bf16 v[104:107], v[216:219], v[184:187], v[104:107]
    ds_read_b64_tr_b16 v[74:75], v18 offset:7760
    v_mfma_f32_16x16x32_bf16 v[112:115], v[220:223], v[184:187], v[112:115]
    ds_read_b128 v[48:51], v11 offset:0
    s_waitcnt lgkmcnt(6)
    s_nop 0
    v_mfma_f32_16x16x32_bf16 v[92:95], v[208:211], v[188:191], v[92:95]
    v_mfma_f32_16x16x32_bf16 v[100:103], v[212:215], v[188:191], v[100:103]
    ds_read_b64_tr_b16 v[76:77], v18 offset:8320
    v_mfma_f32_16x16x32_bf16 v[108:111], v[216:219], v[188:191], v[108:111]
    ds_read_b64_tr_b16 v[78:79], v18 offset:8400
    v_mfma_f32_16x16x32_bf16 v[116:119], v[220:223], v[188:191], v[116:119]
    ds_read_b64_tr_b16 v[80:81], v18 offset:8960
    v_mfma_f32_16x16x32_bf16 v[120:123], v[208:211], v[192:195], v[120:123]
    ds_read_b64_tr_b16 v[82:83], v18 offset:9040
    v_mfma_f32_16x16x32_bf16 v[128:131], v[212:215], v[192:195], v[128:131]
    ds_read_b64_tr_b16 v[84:85], v233 offset:0
    v_mfma_f32_16x16x32_bf16 v[136:139], v[216:219], v[192:195], v[136:139]
    v_mfma_f32_16x16x32_bf16 v[144:147], v[220:223], v[192:195], v[144:147]
    ds_read_b64_tr_b16 v[86:87], v233 offset:80
    s_waitcnt lgkmcnt(9)
    s_nop 0
    v_mfma_f32_16x16x32_bf16 v[124:127], v[208:211], v[196:199], v[124:127]
    v_mfma_f32_16x16x32_bf16 v[132:135], v[212:215], v[196:199], v[132:135]
    ds_read_b128 v[52:55], v11 offset:2048
    v_mfma_f32_16x16x32_bf16 v[140:143], v[216:219], v[196:199], v[140:143]
    v_mfma_f32_16x16x32_bf16 v[148:151], v[220:223], v[196:199], v[148:151]
    ds_read_b128 v[56:59], v11 offset:4096
    v_mfma_f32_16x16x32_bf16 v[152:155], v[208:211], v[200:203], v[152:155]
    v_mfma_f32_16x16x32_bf16 v[160:163], v[212:215], v[200:203], v[160:163]
    ds_read_b128 v[60:63], v11 offset:6144
    v_mfma_f32_16x16x32_bf16 v[168:171], v[216:219], v[200:203], v[168:171]
    v_mfma_f32_16x16x32_bf16 v[176:179], v[220:223], v[200:203], v[176:179]
    ds_read_b128 v[64:67], v11 offset:8192
    v_mfma_f32_16x16x32_bf16 v[156:159], v[208:211], v[204:207], v[156:159]
    v_mfma_f32_16x16x32_bf16 v[164:167], v[212:215], v[204:207], v[164:167]
    ds_read_b128 v[68:71], v11 offset:10240
    v_mfma_f32_16x16x32_bf16 v[172:175], v[216:219], v[204:207], v[172:175]
    v_mfma_f32_16x16x32_bf16 v[180:183], v[220:223], v[204:207], v[180:183]
    s_waitcnt lgkmcnt(5)
    v_mfma_f32_16x16x32_bf16 v[88:91], v[72:75], v[48:51], v[88:91]
    s_barrier
    v_mfma_f32_16x16x32_bf16 v[96:99], v[76:79], v[48:51], v[96:99]
    ds_read_b64_tr_b16 v[208:209], v18 offset:39936
    v_mfma_f32_16x16x32_bf16 v[104:107], v[80:83], v[48:51], v[104:107]
    ds_read_b64_tr_b16 v[210:211], v18 offset:40016
    v_mfma_f32_16x16x32_bf16 v[112:115], v[84:87], v[48:51], v[112:115]
    ds_read_b128 v[184:187], v10 offset:39936
    s_waitcnt lgkmcnt(6)
    s_nop 0
    v_mfma_f32_16x16x32_bf16 v[92:95], v[72:75], v[52:55], v[92:95]
    v_mfma_f32_16x16x32_bf16 v[100:103], v[76:79], v[52:55], v[100:103]
    ds_read_b64_tr_b16 v[212:213], v18 offset:40576
    v_mfma_f32_16x16x32_bf16 v[108:111], v[80:83], v[52:55], v[108:111]
    ds_read_b64_tr_b16 v[214:215], v18 offset:40656
    v_mfma_f32_16x16x32_bf16 v[116:119], v[84:87], v[52:55], v[116:119]
    ds_read_b64_tr_b16 v[216:217], v18 offset:41216
    v_mfma_f32_16x16x32_bf16 v[120:123], v[72:75], v[56:59], v[120:123]
    ds_read_b64_tr_b16 v[218:219], v18 offset:41296
    v_mfma_f32_16x16x32_bf16 v[128:131], v[76:79], v[56:59], v[128:131]
    ds_read_b64_tr_b16 v[220:221], v234 offset:0
    v_mfma_f32_16x16x32_bf16 v[136:139], v[80:83], v[56:59], v[136:139]
    v_mfma_f32_16x16x32_bf16 v[144:147], v[84:87], v[56:59], v[144:147]
    ds_read_b64_tr_b16 v[222:223], v234 offset:80
    s_waitcnt lgkmcnt(9)
    s_nop 0
    v_mfma_f32_16x16x32_bf16 v[124:127], v[72:75], v[60:63], v[124:127]
    v_mfma_f32_16x16x32_bf16 v[132:135], v[76:79], v[60:63], v[132:135]
    ds_read_b128 v[188:191], v10 offset:41984
    v_mfma_f32_16x16x32_bf16 v[140:143], v[80:83], v[60:63], v[140:143]
    v_mfma_f32_16x16x32_bf16 v[148:151], v[84:87], v[60:63], v[148:151]
    ds_read_b128 v[192:195], v10 offset:44032
    v_mfma_f32_16x16x32_bf16 v[152:155], v[72:75], v[64:67], v[152:155]
    v_mfma_f32_16x16x32_bf16 v[160:163], v[76:79], v[64:67], v[160:163]
    ds_read_b128 v[196:199], v10 offset:46080
    v_mfma_f32_16x16x32_bf16 v[168:171], v[80:83], v[64:67], v[168:171]
    v_mfma_f32_16x16x32_bf16 v[176:179], v[84:87], v[64:67], v[176:179]
    ds_read_b128 v[200:203], v10 offset:48128
    v_mfma_f32_16x16x32_bf16 v[156:159], v[72:75], v[68:71], v[156:159]
    v_mfma_f32_16x16x32_bf16 v[164:167], v[76:79], v[68:71], v[164:167]
    ds_read_b128 v[204:207], v10 offset:50176
    v_mfma_f32_16x16x32_bf16 v[172:175], v[80:83], v[68:71], v[172:175]
    v_mfma_f32_16x16x32_bf16 v[180:183], v[84:87], v[68:71], v[180:183]
    s_waitcnt lgkmcnt(5)
    s_nop 0
    v_mfma_f32_16x16x32_bf16 v[88:91], v[208:211], v[184:187], v[88:91]
    v_mfma_f32_16x16x32_bf16 v[96:99], v[212:215], v[184:187], v[96:99]
    ds_read_b64_tr_b16 v[72:73], v18 offset:47616
    v_mfma_f32_16x16x32_bf16 v[104:107], v[216:219], v[184:187], v[104:107]
    ds_read_b64_tr_b16 v[74:75], v18 offset:47696
    v_mfma_f32_16x16x32_bf16 v[112:115], v[220:223], v[184:187], v[112:115]
    ds_read_b128 v[48:51], v11 offset:39936
    s_waitcnt lgkmcnt(6)
    s_nop 0
    v_mfma_f32_16x16x32_bf16 v[92:95], v[208:211], v[188:191], v[92:95]
    v_mfma_f32_16x16x32_bf16 v[100:103], v[212:215], v[188:191], v[100:103]
    ds_read_b64_tr_b16 v[76:77], v18 offset:48256
    v_mfma_f32_16x16x32_bf16 v[108:111], v[216:219], v[188:191], v[108:111]
    ds_read_b64_tr_b16 v[78:79], v18 offset:48336
    v_mfma_f32_16x16x32_bf16 v[116:119], v[220:223], v[188:191], v[116:119]
    ds_read_b64_tr_b16 v[80:81], v18 offset:48896
    v_mfma_f32_16x16x32_bf16 v[120:123], v[208:211], v[192:195], v[120:123]
    ds_read_b64_tr_b16 v[82:83], v18 offset:48976
    v_mfma_f32_16x16x32_bf16 v[128:131], v[212:215], v[192:195], v[128:131]
    ds_read_b64_tr_b16 v[84:85], v235 offset:0
    v_mfma_f32_16x16x32_bf16 v[136:139], v[216:219], v[192:195], v[136:139]
    v_mfma_f32_16x16x32_bf16 v[144:147], v[220:223], v[192:195], v[144:147]
    ds_read_b64_tr_b16 v[86:87], v235 offset:80
    s_waitcnt lgkmcnt(9)
    s_nop 0
    v_mfma_f32_16x16x32_bf16 v[124:127], v[208:211], v[196:199], v[124:127]
    v_mfma_f32_16x16x32_bf16 v[132:135], v[212:215], v[196:199], v[132:135]
    ds_read_b128 v[52:55], v11 offset:41984
    v_mfma_f32_16x16x32_bf16 v[140:143], v[216:219], v[196:199], v[140:143]
    v_mfma_f32_16x16x32_bf16 v[148:151], v[220:223], v[196:199], v[148:151]
    ds_read_b128 v[56:59], v11 offset:44032
    v_mfma_f32_16x16x32_bf16 v[152:155], v[208:211], v[200:203], v[152:155]
    v_mfma_f32_16x16x32_bf16 v[160:163], v[212:215], v[200:203], v[160:163]
    ds_read_b128 v[60:63], v11 offset:46080
    v_mfma_f32_16x16x32_bf16 v[168:171], v[216:219], v[200:203], v[168:171]
    v_mfma_f32_16x16x32_bf16 v[176:179], v[220:223], v[200:203], v[176:179]
    ds_read_b128 v[64:67], v11 offset:48128
    v_mfma_f32_16x16x32_bf16 v[156:159], v[208:211], v[204:207], v[156:159]
    v_mfma_f32_16x16x32_bf16 v[164:167], v[212:215], v[204:207], v[164:167]
    ds_read_b128 v[68:71], v11 offset:50176
    v_mfma_f32_16x16x32_bf16 v[172:175], v[216:219], v[204:207], v[172:175]
    v_mfma_f32_16x16x32_bf16 v[180:183], v[220:223], v[204:207], v[180:183]
    s_waitcnt lgkmcnt(5)
    v_mfma_f32_16x16x32_bf16 v[88:91], v[72:75], v[48:51], v[88:91]
    s_barrier
    v_mfma_f32_16x16x32_bf16 v[96:99], v[76:79], v[48:51], v[96:99]
    ds_read_b64_tr_b16 v[208:209], v16 offset:0
    v_mfma_f32_16x16x32_bf16 v[104:107], v[80:83], v[48:51], v[104:107]
    ds_read_b64_tr_b16 v[210:211], v16 offset:80
    v_mfma_f32_16x16x32_bf16 v[112:115], v[84:87], v[48:51], v[112:115]
    ds_read_b128 v[184:187], v8 offset:0
    s_waitcnt lgkmcnt(6)
    s_nop 0
    v_mfma_f32_16x16x32_bf16 v[92:95], v[72:75], v[52:55], v[92:95]
    v_mfma_f32_16x16x32_bf16 v[100:103], v[76:79], v[52:55], v[100:103]
    ds_read_b64_tr_b16 v[212:213], v16 offset:640
    v_mfma_f32_16x16x32_bf16 v[108:111], v[80:83], v[52:55], v[108:111]
    ds_read_b64_tr_b16 v[214:215], v16 offset:720
    v_mfma_f32_16x16x32_bf16 v[116:119], v[84:87], v[52:55], v[116:119]
    ds_read_b64_tr_b16 v[216:217], v16 offset:1280
    v_mfma_f32_16x16x32_bf16 v[120:123], v[72:75], v[56:59], v[120:123]
    ds_read_b64_tr_b16 v[218:219], v16 offset:1360
    v_mfma_f32_16x16x32_bf16 v[128:131], v[76:79], v[56:59], v[128:131]
    ds_read_b64_tr_b16 v[220:221], v228 offset:0
    v_mfma_f32_16x16x32_bf16 v[136:139], v[80:83], v[56:59], v[136:139]
    v_mfma_f32_16x16x32_bf16 v[144:147], v[84:87], v[56:59], v[144:147]
    ds_read_b64_tr_b16 v[222:223], v228 offset:80
    s_waitcnt lgkmcnt(9)
    s_nop 0
    v_mfma_f32_16x16x32_bf16 v[124:127], v[72:75], v[60:63], v[124:127]
    v_mfma_f32_16x16x32_bf16 v[132:135], v[76:79], v[60:63], v[132:135]
    ds_read_b128 v[188:191], v8 offset:2048
    v_mfma_f32_16x16x32_bf16 v[140:143], v[80:83], v[60:63], v[140:143]
    v_mfma_f32_16x16x32_bf16 v[148:151], v[84:87], v[60:63], v[148:151]
    ds_read_b128 v[192:195], v8 offset:4096
    v_mfma_f32_16x16x32_bf16 v[152:155], v[72:75], v[64:67], v[152:155]
    v_mfma_f32_16x16x32_bf16 v[160:163], v[76:79], v[64:67], v[160:163]
    ds_read_b128 v[196:199], v8 offset:6144
    v_mfma_f32_16x16x32_bf16 v[168:171], v[80:83], v[64:67], v[168:171]
    v_mfma_f32_16x16x32_bf16 v[176:179], v[84:87], v[64:67], v[176:179]
    ds_read_b128 v[200:203], v8 offset:8192
    v_mfma_f32_16x16x32_bf16 v[156:159], v[72:75], v[68:71], v[156:159]
    v_mfma_f32_16x16x32_bf16 v[164:167], v[76:79], v[68:71], v[164:167]
    ds_read_b128 v[204:207], v8 offset:10240
    v_mfma_f32_16x16x32_bf16 v[172:175], v[80:83], v[68:71], v[172:175]
    v_mfma_f32_16x16x32_bf16 v[180:183], v[84:87], v[68:71], v[180:183]
    s_waitcnt lgkmcnt(5)
    s_nop 0
    v_mfma_f32_16x16x32_bf16 v[88:91], v[208:211], v[184:187], v[88:91]
    v_mfma_f32_16x16x32_bf16 v[96:99], v[212:215], v[184:187], v[96:99]
    ds_read_b64_tr_b16 v[72:73], v16 offset:7680
    v_mfma_f32_16x16x32_bf16 v[104:107], v[216:219], v[184:187], v[104:107]
    ds_read_b64_tr_b16 v[74:75], v16 offset:7760
    v_mfma_f32_16x16x32_bf16 v[112:115], v[220:223], v[184:187], v[112:115]
    ds_read_b128 v[48:51], v9 offset:0
    s_waitcnt lgkmcnt(6)
    s_nop 0
    v_mfma_f32_16x16x32_bf16 v[92:95], v[208:211], v[188:191], v[92:95]
    v_mfma_f32_16x16x32_bf16 v[100:103], v[212:215], v[188:191], v[100:103]
    ds_read_b64_tr_b16 v[76:77], v16 offset:8320
    v_mfma_f32_16x16x32_bf16 v[108:111], v[216:219], v[188:191], v[108:111]
    ds_read_b64_tr_b16 v[78:79], v16 offset:8400
    v_mfma_f32_16x16x32_bf16 v[116:119], v[220:223], v[188:191], v[116:119]
    ds_read_b64_tr_b16 v[80:81], v16 offset:8960
    v_mfma_f32_16x16x32_bf16 v[120:123], v[208:211], v[192:195], v[120:123]
    ds_read_b64_tr_b16 v[82:83], v16 offset:9040
    v_mfma_f32_16x16x32_bf16 v[128:131], v[212:215], v[192:195], v[128:131]
    ds_read_b64_tr_b16 v[84:85], v229 offset:0
    v_mfma_f32_16x16x32_bf16 v[136:139], v[216:219], v[192:195], v[136:139]
    v_mfma_f32_16x16x32_bf16 v[144:147], v[220:223], v[192:195], v[144:147]
    ds_read_b64_tr_b16 v[86:87], v229 offset:80
    s_waitcnt lgkmcnt(9)
    s_nop 0
    v_mfma_f32_16x16x32_bf16 v[124:127], v[208:211], v[196:199], v[124:127]
    v_mfma_f32_16x16x32_bf16 v[132:135], v[212:215], v[196:199], v[132:135]
    ds_read_b128 v[52:55], v9 offset:2048
    v_mfma_f32_16x16x32_bf16 v[140:143], v[216:219], v[196:199], v[140:143]
    v_mfma_f32_16x16x32_bf16 v[148:151], v[220:223], v[196:199], v[148:151]
    ds_read_b128 v[56:59], v9 offset:4096
    v_mfma_f32_16x16x32_bf16 v[152:155], v[208:211], v[200:203], v[152:155]
    v_mfma_f32_16x16x32_bf16 v[160:163], v[212:215], v[200:203], v[160:163]
    ds_read_b128 v[60:63], v9 offset:6144
    v_mfma_f32_16x16x32_bf16 v[168:171], v[216:219], v[200:203], v[168:171]
    v_mfma_f32_16x16x32_bf16 v[176:179], v[220:223], v[200:203], v[176:179]
    ds_read_b128 v[64:67], v9 offset:8192
    v_mfma_f32_16x16x32_bf16 v[156:159], v[208:211], v[204:207], v[156:159]
    v_mfma_f32_16x16x32_bf16 v[164:167], v[212:215], v[204:207], v[164:167]
    ds_read_b128 v[68:71], v9 offset:10240
    v_mfma_f32_16x16x32_bf16 v[172:175], v[216:219], v[204:207], v[172:175]
    v_mfma_f32_16x16x32_bf16 v[180:183], v[220:223], v[204:207], v[180:183]
    s_waitcnt lgkmcnt(5)
    v_mfma_f32_16x16x32_bf16 v[88:91], v[72:75], v[48:51], v[88:91]
    s_barrier
    v_mfma_f32_16x16x32_bf16 v[96:99], v[76:79], v[48:51], v[96:99]
    ds_read_b64_tr_b16 v[208:209], v16 offset:39936
    v_mfma_f32_16x16x32_bf16 v[104:107], v[80:83], v[48:51], v[104:107]
    ds_read_b64_tr_b16 v[210:211], v16 offset:40016
    v_mfma_f32_16x16x32_bf16 v[112:115], v[84:87], v[48:51], v[112:115]
    ds_read_b128 v[184:187], v8 offset:39936
    s_waitcnt lgkmcnt(6)
    s_nop 0
    v_mfma_f32_16x16x32_bf16 v[92:95], v[72:75], v[52:55], v[92:95]
    v_mfma_f32_16x16x32_bf16 v[100:103], v[76:79], v[52:55], v[100:103]
    ds_read_b64_tr_b16 v[212:213], v16 offset:40576
    v_mfma_f32_16x16x32_bf16 v[108:111], v[80:83], v[52:55], v[108:111]
    ds_read_b64_tr_b16 v[214:215], v16 offset:40656
    v_mfma_f32_16x16x32_bf16 v[116:119], v[84:87], v[52:55], v[116:119]
    ds_read_b64_tr_b16 v[216:217], v16 offset:41216
    v_mfma_f32_16x16x32_bf16 v[120:123], v[72:75], v[56:59], v[120:123]
    ds_read_b64_tr_b16 v[218:219], v16 offset:41296
    v_mfma_f32_16x16x32_bf16 v[128:131], v[76:79], v[56:59], v[128:131]
    ds_read_b64_tr_b16 v[220:221], v230 offset:0
    v_mfma_f32_16x16x32_bf16 v[136:139], v[80:83], v[56:59], v[136:139]
    v_mfma_f32_16x16x32_bf16 v[144:147], v[84:87], v[56:59], v[144:147]
    ds_read_b64_tr_b16 v[222:223], v230 offset:80
    s_waitcnt lgkmcnt(9)
    s_nop 0
    v_mfma_f32_16x16x32_bf16 v[124:127], v[72:75], v[60:63], v[124:127]
    v_mfma_f32_16x16x32_bf16 v[132:135], v[76:79], v[60:63], v[132:135]
    ds_read_b128 v[188:191], v8 offset:41984
    v_mfma_f32_16x16x32_bf16 v[140:143], v[80:83], v[60:63], v[140:143]
    v_mfma_f32_16x16x32_bf16 v[148:151], v[84:87], v[60:63], v[148:151]
    ds_read_b128 v[192:195], v8 offset:44032
    v_mfma_f32_16x16x32_bf16 v[152:155], v[72:75], v[64:67], v[152:155]
    v_mfma_f32_16x16x32_bf16 v[160:163], v[76:79], v[64:67], v[160:163]
    ds_read_b128 v[196:199], v8 offset:46080
    v_mfma_f32_16x16x32_bf16 v[168:171], v[80:83], v[64:67], v[168:171]
    v_mfma_f32_16x16x32_bf16 v[176:179], v[84:87], v[64:67], v[176:179]
    ds_read_b128 v[200:203], v8 offset:48128
    v_mfma_f32_16x16x32_bf16 v[156:159], v[72:75], v[68:71], v[156:159]
    v_mfma_f32_16x16x32_bf16 v[164:167], v[76:79], v[68:71], v[164:167]
    ds_read_b128 v[204:207], v8 offset:50176
    v_mfma_f32_16x16x32_bf16 v[172:175], v[80:83], v[68:71], v[172:175]
    v_mfma_f32_16x16x32_bf16 v[180:183], v[84:87], v[68:71], v[180:183]
    s_waitcnt lgkmcnt(5)
    s_nop 0
    v_mfma_f32_16x16x32_bf16 v[88:91], v[208:211], v[184:187], v[88:91]
    v_mfma_f32_16x16x32_bf16 v[96:99], v[212:215], v[184:187], v[96:99]
    ds_read_b64_tr_b16 v[72:73], v16 offset:47616
    v_mfma_f32_16x16x32_bf16 v[104:107], v[216:219], v[184:187], v[104:107]
    ds_read_b64_tr_b16 v[74:75], v16 offset:47696
    v_mfma_f32_16x16x32_bf16 v[112:115], v[220:223], v[184:187], v[112:115]
    ds_read_b128 v[48:51], v9 offset:39936
    s_waitcnt lgkmcnt(6)
    s_nop 0
    v_mfma_f32_16x16x32_bf16 v[92:95], v[208:211], v[188:191], v[92:95]
    v_mfma_f32_16x16x32_bf16 v[100:103], v[212:215], v[188:191], v[100:103]
    ds_read_b64_tr_b16 v[76:77], v16 offset:48256
    v_mfma_f32_16x16x32_bf16 v[108:111], v[216:219], v[188:191], v[108:111]
    ds_read_b64_tr_b16 v[78:79], v16 offset:48336
    v_mfma_f32_16x16x32_bf16 v[116:119], v[220:223], v[188:191], v[116:119]
    ds_read_b64_tr_b16 v[80:81], v16 offset:48896
    v_mfma_f32_16x16x32_bf16 v[120:123], v[208:211], v[192:195], v[120:123]
    ds_read_b64_tr_b16 v[82:83], v16 offset:48976
    v_mfma_f32_16x16x32_bf16 v[128:131], v[212:215], v[192:195], v[128:131]
    ds_read_b64_tr_b16 v[84:85], v231 offset:0
    v_mfma_f32_16x16x32_bf16 v[136:139], v[216:219], v[192:195], v[136:139]
    v_mfma_f32_16x16x32_bf16 v[144:147], v[220:223], v[192:195], v[144:147]
    ds_read_b64_tr_b16 v[86:87], v231 offset:80
    s_waitcnt lgkmcnt(9)
    s_nop 0
    v_mfma_f32_16x16x32_bf16 v[124:127], v[208:211], v[196:199], v[124:127]
    v_mfma_f32_16x16x32_bf16 v[132:135], v[212:215], v[196:199], v[132:135]
    ds_read_b128 v[52:55], v9 offset:41984
    v_mfma_f32_16x16x32_bf16 v[140:143], v[216:219], v[196:199], v[140:143]
    v_mfma_f32_16x16x32_bf16 v[148:151], v[220:223], v[196:199], v[148:151]
    ds_read_b128 v[56:59], v9 offset:44032
    v_mfma_f32_16x16x32_bf16 v[152:155], v[208:211], v[200:203], v[152:155]
    v_mfma_f32_16x16x32_bf16 v[160:163], v[212:215], v[200:203], v[160:163]
    ds_read_b128 v[60:63], v9 offset:46080
    v_mfma_f32_16x16x32_bf16 v[168:171], v[216:219], v[200:203], v[168:171]
    v_mfma_f32_16x16x32_bf16 v[176:179], v[220:223], v[200:203], v[176:179]
    ds_read_b128 v[64:67], v9 offset:48128
    v_mfma_f32_16x16x32_bf16 v[156:159], v[208:211], v[204:207], v[156:159]
    v_mfma_f32_16x16x32_bf16 v[164:167], v[212:215], v[204:207], v[164:167]
    ds_read_b128 v[68:71], v9 offset:50176
    v_mfma_f32_16x16x32_bf16 v[172:175], v[216:219], v[204:207], v[172:175]
    v_mfma_f32_16x16x32_bf16 v[180:183], v[220:223], v[204:207], v[180:183]
    s_waitcnt lgkmcnt(5)
    s_nop 0
    v_mfma_f32_16x16x32_bf16 v[88:91], v[72:75], v[48:51], v[88:91]
    v_mfma_f32_16x16x32_bf16 v[96:99], v[76:79], v[48:51], v[96:99]
    v_mfma_f32_16x16x32_bf16 v[104:107], v[80:83], v[48:51], v[104:107]
    v_mfma_f32_16x16x32_bf16 v[112:115], v[84:87], v[48:51], v[112:115]
    s_mul_i32 s55, s7, 6
    s_mul_i32 s50, s52, 3
    s_add_u32 s55, s55, s50
    s_waitcnt lgkmcnt(3)
    v_mfma_f32_16x16x32_bf16 v[92:95], v[72:75], v[52:55], v[92:95]
    v_mfma_f32_16x16x32_bf16 v[100:103], v[76:79], v[52:55], v[100:103]
    v_mfma_f32_16x16x32_bf16 v[108:111], v[80:83], v[52:55], v[108:111]
    v_mfma_f32_16x16x32_bf16 v[116:119], v[84:87], v[52:55], v[116:119]
    s_cmp_lt_u32 s55, 64
    s_cselect_b32 s50, 0x3f80, 0
    v_mov_b32_e64 v224, s50
    s_cmp_lt_u32 s55, 63
    s_cselect_b32 s50, 0x3f80, 0
    v_mov_b32 v225, s50
    s_waitcnt vmcnt(0)
    v_mfma_f32_16x16x32_bf16 v[120:123], v[72:75], v[56:59], v[120:123]
    v_mfma_f32_16x16x32_bf16 v[128:131], v[76:79], v[56:59], v[128:131]
    v_mfma_f32_16x16x32_bf16 v[136:139], v[80:83], v[56:59], v[136:139]
    v_mfma_f32_16x16x32_bf16 v[144:147], v[84:87], v[56:59], v[144:147]
    s_cmp_lt_u32 s55, 62
    s_cselect_b32 s50, 0x3f80, 0
    v_mov_b32 v226, s50
    v_mov_b32 v18, 0
    v_mov_b32_e64 v19, 0
    s_waitcnt lgkmcnt(0)
    v_mfma_f32_16x16x32_bf16 v[124:127], v[72:75], v[60:63], v[124:127]
    v_cvt_pk_bf16_f32 v184, v96, v97
    v_cvt_pk_bf16_f32 v185, v98, v99
    v_mfma_f32_16x16x32_bf16 v[132:135], v[76:79], v[60:63], v[132:135]
    v_cvt_pk_bf16_f32 v186, v100, v101
    v_cvt_pk_bf16_f32 v187, v102, v103
    v_mfma_f32_16x16x32_bf16 v[140:143], v[80:83], v[60:63], v[140:143]
    v_cvt_pk_bf16_f32 v192, v112, v113
    v_mfma_f32_16x16x32_bf16 v[148:151], v[84:87], v[60:63], v[148:151]
    v_cvt_pk_bf16_f32 v193, v114, v115
    v_cvt_pk_bf16_f32 v194, v116, v117
    v_mfma_f32_16x16x32_bf16 v[152:155], v[72:75], v[64:67], v[152:155]
    v_cvt_pk_bf16_f32 v195, v118, v119
    v_mfma_f32_16x16x32_bf16 v[160:163], v[76:79], v[64:67], v[160:163]
    v_permlane16_swap_b32 v184, v186
    v_permlane16_swap_b32 v185, v187
    v_mfma_f32_16x16x32_bf16 v[168:171], v[80:83], v[64:67], v[168:171]
    v_cvt_pk_bf16_f32 v188, v104, v105
    v_cvt_pk_bf16_f32 v189, v106, v107
    v_mfma_f32_16x16x32_bf16 v[176:179], v[84:87], v[64:67], v[176:179]
    v_cvt_pk_bf16_f32 v190, v108, v109
    v_mfma_f32_16x16x32_bf16 v[156:159], v[72:75], v[68:71], v[156:159]
    v_cvt_pk_bf16_f32 v191, v110, v111
    v_permlane16_swap_b32_e64 v192, v194
    v_mfma_f32_16x16x32_bf16 v[164:167], v[76:79], v[68:71], v[164:167]
    v_permlane16_swap_b32_e64 v193, v195
    v_mfma_f32_16x16x32_bf16 v[172:175], v[80:83], v[68:71], v[172:175]
    v_cndmask_b32 v194, v194, v224, s[58:59]
    v_permlane16_swap_b32_e64 v188, v190
    v_mfma_f32_16x16x32_bf16 v[180:183], v[84:87], v[68:71], v[180:183]
    v_permlane16_swap_b32_e64 v189, v191
    v_cvt_pk_bf16_f32 v196, v128, v129
    v_cvt_pk_bf16_f32 v197, v130, v131
    v_cvt_pk_bf16_f32 v198, v132, v133
    v_mfma_f32_32x32x16_bf16 v[104:119], v[20:23], v[184:187], 0
    v_cvt_pk_bf16_f32 v199, v134, v135
    v_cvt_pk_bf16_f32 v204, v144, v145
    v_cvt_pk_bf16_f32 v205, v146, v147
    v_cvt_pk_bf16_f32 v206, v148, v149
    v_cvt_pk_bf16_f32 v207, v150, v151
    v_permlane16_swap_b32_e64 v196, v198
    v_mfma_f32_32x32x16_bf16 v[104:119], v[28:31], v[192:195], v[104:119]
    v_permlane16_swap_b32_e64 v197, v199
    v_cvt_pk_bf16_f32 v200, v136, v137
    v_cvt_pk_bf16_f32 v201, v138, v139
    v_cvt_pk_bf16_f32 v202, v140, v141
    v_cvt_pk_bf16_f32 v203, v142, v143
    v_permlane16_swap_b32 v204, v206
    v_permlane16_swap_b32 v205, v207
    v_cndmask_b32 v206, v206, v225, s[58:59]
    v_permlane16_swap_b32 v200, v202
    v_permlane16_swap_b32 v201, v203
    v_cvt_pk_bf16_f32 v208, v160, v161
    v_cvt_pk_bf16_f32 v209, v162, v163
    v_cvt_pk_bf16_f32 v210, v164, v165
    v_cvt_pk_bf16_f32 v211, v166, v167
    v_cvt_pk_bf16_f32 v216, v176, v177
    v_cvt_pk_bf16_f32 v217, v178, v179
    v_cvt_pk_bf16_f32 v218, v180, v181
    v_cvt_pk_bf16_f32 v219, v182, v183
    v_permlane16_swap_b32 v208, v210
    v_permlane16_swap_b32 v209, v211
    v_cvt_pk_bf16_f32 v212, v168, v169
    v_cvt_pk_bf16_f32 v213, v170, v171
    v_cvt_pk_bf16_f32 v214, v172, v173
    v_cvt_pk_bf16_f32 v215, v174, v175
    v_permlane16_swap_b32 v216, v218
    v_permlane16_swap_b32 v217, v219
    v_cndmask_b32 v218, v218, v226, s[58:59]
    v_permlane16_swap_b32 v212, v214
    v_permlane16_swap_b32 v213, v215
    v_max3_f32 v84, v104, v105, v106
    v_max3_f32 v85, -v104, -v105, -v106
    v_max3_f32 v84, v84, v107, v108
    v_max3_f32 v85, v85, -v107, -v108
    v_max3_f32 v84, v84, v109, v110
    v_max3_f32 v85, v85, -v109, -v110
    v_max3_f32 v84, v84, v111, v112
    v_max3_f32 v85, v85, -v111, -v112
    v_max_f32_e64 v84, v84, v113
    v_max_f32_e64 v85, v85, -v113
    s_nop 1
    v_permlane32_swap_b32 v84, v85
    v_max_f32 v86, v84, v85
    v_mul_f32 v84, s61, v86
    v_mul_f32 v85, s61, v86
    s_nop 1
    v_permlane32_swap_b32_e64 v84, v85
    v_pk_fma_f32 v[236:237], v[104:105], s[60:61], v[84:85] op_sel:[0,0,0] op_sel_hi:[0,1,1]
    v_pk_fma_f32 v[238:239], v[104:105], s[60:61], v[84:85] op_sel:[1,0,0] op_sel_hi:[1,1,1]
    v_pk_fma_f32 v[240:241], v[106:107], s[60:61], v[84:85] op_sel:[0,0,0] op_sel_hi:[0,1,1]
    v_pk_fma_f32 v[242:243], v[106:107], s[60:61], v[84:85] op_sel:[1,0,0] op_sel_hi:[1,1,1]
    v_pk_fma_f32 v[244:245], v[108:109], s[60:61], v[84:85] op_sel:[0,0,0] op_sel_hi:[0,1,1]
    v_pk_fma_f32 v[246:247], v[108:109], s[60:61], v[84:85] op_sel:[1,0,0] op_sel_hi:[1,1,1]
    v_pk_fma_f32 v[248:249], v[110:111], s[60:61], v[84:85] op_sel:[0,0,0] op_sel_hi:[0,1,1]
    v_pk_fma_f32 v[250:251], v[110:111], s[60:61], v[84:85] op_sel:[1,0,0] op_sel_hi:[1,1,1]
    v_pk_fma_f32 v[252:253], v[112:113], s[60:61], v[84:85] op_sel:[0,0,0] op_sel_hi:[0,1,1]
    v_pk_fma_f32 v[254:255], v[112:113], s[60:61], v[84:85] op_sel:[1,0,0] op_sel_hi:[1,1,1]
    v_mfma_f32_32x32x16_bf16 v[136:151], v[20:23], v[196:199], 0
    v_exp_f32 v236, v236
    v_exp_f32 v237, v237
    v_exp_f32 v238, v238
    v_exp_f32 v239, v239
    v_mfma_f32_32x32x16_bf16 v[136:151], v[28:31], v[204:207], v[136:151]
    v_exp_f32 v240, v240
    v_exp_f32 v241, v241
    v_exp_f32 v242, v242
    v_exp_f32 v243, v243
    v_mfma_f32_32x32x16_bf16 v[168:183], v[20:23], v[208:211], 0
    v_exp_f32 v244, v244
    v_exp_f32 v245, v245
    v_exp_f32 v246, v246
    v_exp_f32 v247, v247
    v_mfma_f32_32x32x16_bf16 v[168:183], v[28:31], v[216:219], v[168:183]
    v_exp_f32 v248, v248
    v_exp_f32 v249, v249
    v_exp_f32 v250, v250
    v_exp_f32 v251, v251
    v_exp_f32 v252, v252
    v_exp_f32 v253, v253
    v_exp_f32 v254, v254
    v_exp_f32 v255, v255
    v_pk_add_f32 v[86:87], v[236:237], v[238:239]
    v_pk_add_f32 v[84:85], v[240:241], v[242:243]
    v_pk_add_f32 v[86:87], v[86:87], v[244:245]
    v_pk_add_f32 v[84:85], v[84:85], v[246:247]
    v_pk_add_f32 v[86:87], v[86:87], v[248:249]
    v_pk_add_f32 v[84:85], v[84:85], v[250:251]
    v_pk_add_f32 v[86:87], v[86:87], v[252:253]
    v_pk_add_f32 v[84:85], v[84:85], v[254:255]
    v_pk_add_f32 v[86:87], v[86:87], v[84:85]
    v_mfma_f32_32x32x16_bf16 v[220:235], v[188:191], v[40:43], 0
    v_max3_f32 v80, v136, v137, v138
    v_max3_f32 v81, -v136, -v137, -v138
    v_permlane32_swap_b32 v86, v87
    v_add_f32 v86, v86, v87
    v_max3_f32 v80, v80, v139, v140
    v_mfma_f32_32x32x16_bf16 v[220:235], v[192:195], v[44:47], v[220:235]
    v_max3_f32 v81, v81, -v139, -v140
    v_rcp_f32_e64 v84, v86
    v_max3_f32 v80, v80, v141, v142
    v_max3_f32 v81, v81, -v141, -v142
    v_mov_b32_e64 v85, v84
    v_max3_f32 v80, v80, v143, v144
    v_max3_f32 v81, v81, -v143, -v144
    v_max_f32_e64 v80, v80, v145
    v_max_f32_e64 v81, v81, -v145
    v_permlane32_swap_b32_e64 v84, v85
    v_pk_mul_f32 v[236:237], v[236:237], v[84:85]
    v_permlane32_swap_b32 v80, v81
    v_max_f32 v82, v80, v81
    v_mul_f32 v80, s61, v82
    v_mul_f32 v81, s61, v82
    v_pk_mul_f32 v[238:239], v[238:239], v[84:85]
    v_pk_mul_f32 v[240:241], v[240:241], v[84:85]
    v_permlane32_swap_b32_e64 v80, v81
    v_cvt_pk_bf16_f32 v8, v236, v237
    v_pk_mul_f32 v[242:243], v[242:243], v[84:85]
    v_cvt_pk_bf16_f32 v9, v238, v239
    v_pk_mul_f32 v[244:245], v[244:245], v[84:85]
    v_cvt_pk_bf16_f32 v10, v240, v241
    v_pk_mul_f32 v[246:247], v[246:247], v[84:85]
    v_cvt_pk_bf16_f32 v11, v242, v243
    v_pk_mul_f32 v[248:249], v[248:249], v[84:85]
    v_cvt_pk_bf16_f32 v12, v244, v245
    v_pk_mul_f32 v[250:251], v[250:251], v[84:85]
    v_cvt_pk_bf16_f32 v13, v246, v247
    v_pk_mul_f32 v[252:253], v[252:253], v[84:85]
    v_cvt_pk_bf16_f32 v14, v248, v249
    v_pk_mul_f32 v[254:255], v[254:255], v[84:85]
    v_cvt_pk_bf16_f32 v15, v250, v251
    v_cvt_pk_bf16_f32 v16, v252, v253
    v_cvt_pk_bf16_f32 v17, v254, v255
    v_pk_fma_f32 v[236:237], v[136:137], s[60:61], v[80:81] op_sel:[0,0,0] op_sel_hi:[0,1,1]
    v_pk_fma_f32 v[238:239], v[136:137], s[60:61], v[80:81] op_sel:[1,0,0] op_sel_hi:[1,1,1]
    v_pk_fma_f32 v[240:241], v[138:139], s[60:61], v[80:81] op_sel:[0,0,0] op_sel_hi:[0,1,1]
    v_pk_fma_f32 v[242:243], v[138:139], s[60:61], v[80:81] op_sel:[1,0,0] op_sel_hi:[1,1,1]
    v_pk_fma_f32 v[244:245], v[140:141], s[60:61], v[80:81] op_sel:[0,0,0] op_sel_hi:[0,1,1]
    v_pk_fma_f32 v[246:247], v[140:141], s[60:61], v[80:81] op_sel:[1,0,0] op_sel_hi:[1,1,1]
    v_pk_fma_f32 v[248:249], v[142:143], s[60:61], v[80:81] op_sel:[0,0,0] op_sel_hi:[0,1,1]
    v_pk_fma_f32 v[250:251], v[142:143], s[60:61], v[80:81] op_sel:[1,0,0] op_sel_hi:[1,1,1]
    v_pk_fma_f32 v[252:253], v[144:145], s[60:61], v[80:81] op_sel:[0,0,0] op_sel_hi:[0,1,1]
    v_pk_fma_f32 v[254:255], v[144:145], s[60:61], v[80:81] op_sel:[1,0,0] op_sel_hi:[1,1,1]
    v_mfma_f32_32x32x16_bf16 v[220:235], v[16:19], v[32:35], v[220:235]
    v_exp_f32 v236, v236
    v_exp_f32 v237, v237
    v_exp_f32_e64 v238, v238
    v_mfma_f32_32x32x16_bf16 v[104:119], v[8:11], v[32:35], 0
    v_exp_f32 v239, v239
    v_exp_f32 v240, v240
    v_exp_f32_e64 v241, v241
    v_mfma_f32_32x32x16_bf16 v[104:119], v[12:15], v[36:39], v[104:119]
    v_exp_f32 v242, v242
    v_exp_f32 v243, v243
    v_exp_f32 v244, v244
    v_exp_f32 v245, v245
    v_exp_f32 v246, v246
    v_exp_f32 v247, v247
    v_cvt_pk_bf16_f32 v184, v220, v221
    v_cvt_pk_bf16_f32 v185, v222, v223
    v_cvt_pk_bf16_f32 v186, v224, v225
    v_cvt_pk_bf16_f32 v187, v226, v227
    v_cvt_pk_bf16_f32 v188, v228, v229
    v_cvt_pk_bf16_f32 v189, v230, v231
    v_cvt_pk_bf16_f32 v190, v232, v233
    v_cvt_pk_bf16_f32 v191, v234, v235
    v_mfma_f32_32x32x16_bf16 v[64:79], v[184:187], v[184:187], 0
    v_cvt_pk_bf16_f32 v96, v104, v105
    v_cvt_pk_bf16_f32 v97, v106, v107
    v_cvt_pk_bf16_f32 v98, v108, v109
    v_cvt_pk_bf16_f32 v99, v110, v111
    v_cvt_pk_bf16_f32 v100, v112, v113
    v_cvt_pk_bf16_f32 v101, v114, v115
    v_mfma_f32_32x32x16_bf16 v[64:79], v[188:191], v[188:191], v[64:79]
    v_cvt_pk_bf16_f32 v102, v116, v117
    v_cvt_pk_bf16_f32 v103, v118, v119
    v_exp_f32 v248, v248
    v_exp_f32 v249, v249
    v_mfma_f32_32x32x16_bf16 v[48:63], v[96:99], v[184:187], 0
    v_exp_f32 v250, v250
    v_exp_f32 v251, v251
    v_exp_f32_e64 v252, v252
    v_mfma_f32_32x32x16_bf16 v[48:63], v[100:103], v[188:191], v[48:63]
    v_exp_f32 v253, v253
    v_exp_f32 v254, v254
    v_exp_f32_e64 v255, v255
    v_pk_add_f32 v[82:83], v[236:237], v[238:239]
    v_pk_add_f32 v[80:81], v[240:241], v[242:243]
    v_pk_add_f32 v[82:83], v[82:83], v[244:245]
    v_pk_add_f32 v[80:81], v[80:81], v[246:247]
    v_pk_add_f32 v[82:83], v[82:83], v[248:249]
    v_pk_add_f32 v[80:81], v[80:81], v[250:251]
    v_pk_add_f32 v[82:83], v[82:83], v[252:253]
    v_pk_add_f32 v[80:81], v[80:81], v[254:255]
PG_B2:
    s_cbranch_execz PG_B3
    s_nop 0
    v_pk_add_f32 v[82:83], v[82:83], v[80:81]
    v_mfma_f32_32x32x16_bf16 v[220:235], v[200:203], v[40:43], 0
    v_max3_f32 v84, v168, v169, v170
    v_max3_f32 v85, -v168, -v169, -v170
    v_permlane32_swap_b32 v82, v83
    v_add_f32 v82, v82, v83
    v_max3_f32 v84, v84, v171, v172
    v_mfma_f32_32x32x16_bf16 v[220:235], v[204:207], v[44:47], v[220:235]
    v_max3_f32 v85, v85, -v171, -v172
    v_rcp_f32_e64 v80, v82
    v_max3_f32 v84, v84, v173, v174
    v_max3_f32 v85, v85, -v173, -v174
    v_mov_b32_e64 v81, v80
    v_max3_f32 v84, v84, v175, v176
    v_max3_f32 v85, v85, -v175, -v176
    v_max_f32_e64 v84, v84, v177
    v_max_f32_e64 v85, v85, -v177
    v_permlane32_swap_b32_e64 v80, v81
    v_pk_mul_f32 v[236:237], v[236:237], v[80:81]
    v_permlane32_swap_b32 v84, v85
    v_max_f32 v86, v84, v85
    v_mul_f32 v84, s61, v86
    v_mul_f32 v85, s61, v86
    v_pk_mul_f32 v[238:239], v[238:239], v[80:81]
    v_pk_mul_f32 v[240:241], v[240:241], v[80:81]
    v_permlane32_swap_b32_e64 v84, v85
    v_cvt_pk_bf16_f32 v8, v236, v237
    v_pk_mul_f32 v[242:243], v[242:243], v[80:81]
    v_cvt_pk_bf16_f32 v9, v238, v239
    v_pk_mul_f32 v[244:245], v[244:245], v[80:81]
    v_cvt_pk_bf16_f32 v10, v240, v241
    v_pk_mul_f32 v[246:247], v[246:247], v[80:81]
    v_cvt_pk_bf16_f32 v11, v242, v243
    v_pk_mul_f32 v[248:249], v[248:249], v[80:81]
    v_cvt_pk_bf16_f32 v12, v244, v245
    v_pk_mul_f32 v[250:251], v[250:251], v[80:81]
    v_cvt_pk_bf16_f32 v13, v246, v247
    v_pk_mul_f32 v[252:253], v[252:253], v[80:81]
    v_cvt_pk_bf16_f32 v14, v248, v249
    v_pk_mul_f32 v[254:255], v[254:255], v[80:81]
    v_cvt_pk_bf16_f32 v15, v250, v251
    v_cvt_pk_bf16_f32 v16, v252, v253
    v_cvt_pk_bf16_f32 v17, v254, v255
    v_pk_fma_f32 v[236:237], v[168:169], s[60:61], v[84:85] op_sel:[0,0,0] op_sel_hi:[0,1,1]
    v_pk_fma_f32 v[238:239], v[168:169], s[60:61], v[84:85] op_sel:[1,0,0] op_sel_hi:[1,1,1]
    v_pk_fma_f32 v[240:241], v[170:171], s[60:61], v[84:85] op_sel:[0,0,0] op_sel_hi:[0,1,1]
    v_pk_fma_f32 v[242:243], v[170:171], s[60:61], v[84:85] op_sel:[1,0,0] op_sel_hi:[1,1,1]
    v_pk_fma_f32 v[244:245], v[172:173], s[60:61], v[84:85] op_sel:[0,0,0] op_sel_hi:[0,1,1]
    v_pk_fma_f32 v[246:247], v[172:173], s[60:61], v[84:85] op_sel:[1,0,0] op_sel_hi:[1,1,1]
    v_pk_fma_f32 v[248:249], v[174:175], s[60:61], v[84:85] op_sel:[0,0,0] op_sel_hi:[0,1,1]
    v_pk_fma_f32 v[250:251], v[174:175], s[60:61], v[84:85] op_sel:[1,0,0] op_sel_hi:[1,1,1]
    v_pk_fma_f32 v[252:253], v[176:177], s[60:61], v[84:85] op_sel:[0,0,0] op_sel_hi:[0,1,1]
    v_pk_fma_f32 v[254:255], v[176:177], s[60:61], v[84:85] op_sel:[1,0,0] op_sel_hi:[1,1,1]
    v_mfma_f32_32x32x16_bf16 v[220:235], v[16:19], v[32:35], v[220:235]
    v_exp_f32 v236, v236
    v_exp_f32 v237, v237
    v_exp_f32_e64 v238, v238
    v_mfma_f32_32x32x16_bf16 v[136:151], v[8:11], v[32:35], 0
    v_exp_f32 v239, v239
    v_exp_f32 v240, v240
    v_exp_f32_e64 v241, v241
    v_mfma_f32_32x32x16_bf16 v[136:151], v[12:15], v[36:39], v[136:151]
    v_exp_f32 v242, v242
    v_exp_f32 v243, v243
    v_exp_f32 v244, v244
    v_exp_f32 v245, v245
    v_exp_f32 v246, v246
    v_exp_f32 v247, v247
    v_cvt_pk_bf16_f32 v196, v220, v221
    v_cvt_pk_bf16_f32 v197, v222, v223
    v_cvt_pk_bf16_f32 v198, v224, v225
    v_cvt_pk_bf16_f32 v199, v226, v227
    v_cvt_pk_bf16_f32 v200, v228, v229
    v_cvt_pk_bf16_f32 v201, v230, v231
    v_cvt_pk_bf16_f32 v202, v232, v233
    v_cvt_pk_bf16_f32 v203, v234, v235
    v_mfma_f32_32x32x16_bf16 v[64:79], v[196:199], v[196:199], v[64:79]
    v_cvt_pk_bf16_f32 v128, v136, v137
    v_cvt_pk_bf16_f32 v129, v138, v139
    v_cvt_pk_bf16_f32 v130, v140, v141
    v_cvt_pk_bf16_f32 v131, v142, v143
    v_cvt_pk_bf16_f32 v132, v144, v145
    v_cvt_pk_bf16_f32 v133, v146, v147
    v_mfma_f32_32x32x16_bf16 v[64:79], v[200:203], v[200:203], v[64:79]
    v_cvt_pk_bf16_f32 v134, v148, v149
    v_cvt_pk_bf16_f32 v135, v150, v151
    v_exp_f32 v248, v248
    v_exp_f32 v249, v249
    v_mfma_f32_32x32x16_bf16 v[48:63], v[128:131], v[196:199], v[48:63]
    v_exp_f32 v250, v250
    v_exp_f32 v251, v251
    v_exp_f32_e64 v252, v252
    v_mfma_f32_32x32x16_bf16 v[48:63], v[132:135], v[200:203], v[48:63]
    v_exp_f32 v253, v253
    v_exp_f32 v254, v254
    v_exp_f32_e64 v255, v255
    v_pk_add_f32 v[86:87], v[236:237], v[238:239]
    v_pk_add_f32 v[84:85], v[240:241], v[242:243]
    v_pk_add_f32 v[86:87], v[86:87], v[244:245]
    v_pk_add_f32 v[84:85], v[84:85], v[246:247]
    v_pk_add_f32 v[86:87], v[86:87], v[248:249]
    v_pk_add_f32 v[84:85], v[84:85], v[250:251]
    v_pk_add_f32 v[86:87], v[86:87], v[252:253]
    v_pk_add_f32 v[84:85], v[84:85], v[254:255]
    v_pk_add_f32 v[86:87], v[86:87], v[84:85]
    v_mfma_f32_32x32x16_bf16 v[220:235], v[212:215], v[40:43], 0
    s_nop 0
    v_permlane32_swap_b32 v86, v87
    v_add_f32 v86, v86, v87
    v_rcp_f32 v84, v86
    v_mfma_f32_32x32x16_bf16 v[220:235], v[216:219], v[44:47], v[220:235]
    v_mov_b32 v85, v84
    s_nop 1
    v_permlane32_swap_b32_e64 v84, v85
    v_pk_mul_f32 v[252:253], v[252:253], v[84:85]
    v_pk_mul_f32 v[254:255], v[254:255], v[84:85]
    v_pk_mul_f32 v[236:237], v[236:237], v[84:85]
    v_pk_mul_f32 v[238:239], v[238:239], v[84:85]
    v_pk_mul_f32 v[240:241], v[240:241], v[84:85]
    v_pk_mul_f32 v[242:243], v[242:243], v[84:85]
    v_pk_mul_f32 v[244:245], v[244:245], v[84:85]
    v_pk_mul_f32 v[246:247], v[246:247], v[84:85]
    v_pk_mul_f32 v[248:249], v[248:249], v[84:85]
    v_pk_mul_f32 v[250:251], v[250:251], v[84:85]
    v_cvt_pk_bf16_f32 v16, v252, v253
    v_cvt_pk_bf16_f32 v17, v254, v255
    v_cvt_pk_bf16_f32 v8, v236, v237
    v_cvt_pk_bf16_f32 v9, v238, v239
    v_mfma_f32_32x32x16_bf16 v[220:235], v[16:19], v[32:35], v[220:235]
    v_cvt_pk_bf16_f32 v10, v240, v241
    v_cvt_pk_bf16_f32 v11, v242, v243
    v_cvt_pk_bf16_f32 v12, v244, v245
    v_cvt_pk_bf16_f32 v13, v246, v247
    v_cvt_pk_bf16_f32 v14, v248, v249
    v_cvt_pk_bf16_f32 v15, v250, v251
    v_mfma_f32_32x32x16_bf16 v[168:183], v[8:11], v[32:35], 0
    s_mul_i32 s50, s4, 5120
    v_lshl_add_u32 v2, v1, 4, s50
    s_nop 1
    s_nop 0
    v_cvt_pk_bf16_f32 v208, v220, v221
    v_cvt_pk_bf16_f32 v209, v222, v223
    v_mfma_f32_32x32x16_bf16 v[168:183], v[12:15], v[36:39], v[168:183]
    v_cvt_pk_bf16_f32 v210, v224, v225
    v_cvt_pk_bf16_f32 v211, v226, v227
    v_cvt_pk_bf16_f32 v212, v228, v229
    v_cvt_pk_bf16_f32 v213, v230, v231
    v_cvt_pk_bf16_f32 v214, v232, v233
    v_cvt_pk_bf16_f32 v215, v234, v235
    v_mfma_f32_32x32x16_bf16 v[64:79], v[208:211], v[208:211], v[64:79]
    v_cvt_pk_bf16_f32 v220, v88, v89
    v_cvt_pk_bf16_f32 v221, v90, v91
    v_cvt_pk_bf16_f32 v222, v92, v93
    v_cvt_pk_bf16_f32 v223, v94, v95
    v_mfma_f32_32x32x16_bf16 v[64:79], v[212:215], v[212:215], v[64:79]
    v_cvt_pk_bf16_f32 v160, v168, v169
    v_cvt_pk_bf16_f32 v161, v170, v171
    v_cvt_pk_bf16_f32 v162, v172, v173
    v_cvt_pk_bf16_f32 v163, v174, v175
    v_cvt_pk_bf16_f32 v164, v176, v177
    v_cvt_pk_bf16_f32 v165, v178, v179
    v_mfma_f32_32x32x16_bf16 v[48:63], v[160:163], v[208:211], v[48:63]
    v_cvt_pk_bf16_f32 v166, v180, v181
    v_cvt_pk_bf16_f32 v167, v182, v183
    v_cvt_pk_bf16_f32 v224, v120, v121
    v_cvt_pk_bf16_f32 v225, v122, v123
    v_cvt_pk_bf16_f32 v226, v124, v125
    v_cvt_pk_bf16_f32 v227, v126, v127
    v_mfma_f32_32x32x16_bf16 v[48:63], v[164:167], v[212:215], v[48:63]
    v_cvt_pk_bf16_f32 v228, v152, v153
    v_cvt_pk_bf16_f32 v229, v154, v155
    v_cvt_pk_bf16_f32 v230, v156, v157
    v_cvt_pk_bf16_f32 v231, v158, v159
    v_permlane16_swap_b32 v220, v222
    v_permlane16_swap_b32 v221, v223
    ds_write_b128 v2, v[64:67] offset:4096
    s_nop 4
    s_nop 0
    ds_write_b128 v2, v[48:51] offset:0
    ds_write_b128 v2, v[52:55] offset:1024
    ds_write_b128 v2, v[56:59] offset:2048
    ds_write_b128 v2, v[60:63] offset:3072
    v_mfma_f32_32x32x16_bf16 v[104:119], v[20:23], v[220:223], 0
    v_mfma_f32_32x32x16_bf16 v[104:119], v[24:27], v[192:195], v[104:119]
    s_waitcnt lgkmcnt(0)
    s_barrier
    v_mov_b32 v98, 0
    v_mov_b32 v99, 0
    v_mov_b32 v130, 0
    v_mov_b32 v131, 0
    v_mov_b32 v162, 0
    v_mov_b32 v163, 0
    v_permlane16_swap_b32 v224, v226
    v_permlane16_swap_b32 v225, v227
    v_permlane16_swap_b32 v228, v230
    v_permlane16_swap_b32 v229, v231
    v_max3_f32 v84, v104, v105, v106
    v_max3_f32 v85, -v104, -v105, -v106
    v_max3_f32 v84, v84, v107, v108
    v_max3_f32 v85, v85, -v107, -v108
    v_max3_f32 v84, v84, v109, v110
    v_max3_f32 v85, v85, -v109, -v110
    v_max3_f32 v84, v84, v111, v112
    v_max3_f32 v85, v85, -v111, -v112
    v_max_f32_e64 v84, v84, v113
    v_max_f32_e64 v85, v85, -v113
    s_nop 1
    v_permlane32_swap_b32 v84, v85
    v_max_f32 v86, v84, v85
    v_mul_f32 v84, s61, v86
    v_mul_f32 v85, s61, v86
    s_nop 1
    v_permlane32_swap_b32_e64 v84, v85
    v_pk_fma_f32 v[236:237], v[104:105], s[60:61], v[84:85] op_sel:[0,0,0] op_sel_hi:[0,1,1]
    v_pk_fma_f32 v[238:239], v[104:105], s[60:61], v[84:85] op_sel:[1,0,0] op_sel_hi:[1,1,1]
    v_pk_fma_f32 v[240:241], v[106:107], s[60:61], v[84:85] op_sel:[0,0,0] op_sel_hi:[0,1,1]
    v_pk_fma_f32 v[242:243], v[106:107], s[60:61], v[84:85] op_sel:[1,0,0] op_sel_hi:[1,1,1]
    v_pk_fma_f32 v[244:245], v[108:109], s[60:61], v[84:85] op_sel:[0,0,0] op_sel_hi:[0,1,1]
    v_pk_fma_f32 v[246:247], v[108:109], s[60:61], v[84:85] op_sel:[1,0,0] op_sel_hi:[1,1,1]
    v_pk_fma_f32 v[248:249], v[110:111], s[60:61], v[84:85] op_sel:[0,0,0] op_sel_hi:[0,1,1]
    v_pk_fma_f32 v[250:251], v[110:111], s[60:61], v[84:85] op_sel:[1,0,0] op_sel_hi:[1,1,1]
    v_pk_fma_f32 v[252:253], v[112:113], s[60:61], v[84:85] op_sel:[0,0,0] op_sel_hi:[0,1,1]
    v_pk_fma_f32 v[254:255], v[112:113], s[60:61], v[84:85] op_sel:[1,0,0] op_sel_hi:[1,1,1]
    v_mfma_f32_32x32x16_bf16 v[136:151], v[20:23], v[224:227], 0
    v_exp_f32 v236, v236
    v_exp_f32 v237, v237
    v_exp_f32 v238, v238
    v_exp_f32 v239, v239
    v_mfma_f32_32x32x16_bf16 v[136:151], v[24:27], v[204:207], v[136:151]
    v_exp_f32 v240, v240
    v_exp_f32 v241, v241
    v_exp_f32 v242, v242
    v_exp_f32 v243, v243
    v_mfma_f32_32x32x16_bf16 v[168:183], v[20:23], v[228:231], 0
    v_exp_f32 v244, v244
    v_exp_f32 v245, v245
    v_exp_f32 v246, v246
    v_exp_f32 v247, v247
    v_mfma_f32_32x32x16_bf16 v[168:183], v[24:27], v[216:219], v[168:183]
    v_exp_f32 v248, v248
    v_exp_f32 v249, v249
    v_exp_f32 v250, v250
    v_exp_f32 v251, v251
    v_exp_f32 v252, v252
    v_exp_f32 v253, v253
    v_exp_f32 v254, v254
    v_exp_f32 v255, v255
    v_pk_add_f32 v[86:87], v[236:237], v[238:239]
    v_pk_add_f32 v[84:85], v[240:241], v[242:243]
    v_pk_add_f32 v[86:87], v[86:87], v[244:245]
    v_pk_add_f32 v[84:85], v[84:85], v[246:247]
    v_pk_add_f32 v[86:87], v[86:87], v[248:249]
    v_pk_add_f32 v[84:85], v[84:85], v[250:251]
    v_pk_add_f32 v[86:87], v[86:87], v[252:253]
    v_pk_add_f32 v[84:85], v[84:85], v[254:255]
    v_pk_add_f32 v[86:87], v[86:87], v[84:85]
    v_max3_f32 v80, v136, v137, v138
    v_max3_f32 v81, -v136, -v137, -v138
    v_permlane32_swap_b32 v86, v87
    v_add_f32 v86, v86, v87
    v_max3_f32 v80, v80, v139, v140
    v_max3_f32 v81, v81, -v139, -v140
    v_rcp_f32_e64 v84, v86
    v_max3_f32 v80, v80, v141, v142
    v_max3_f32 v81, v81, -v141, -v142
    v_mov_b32_e64 v85, v84
    v_max3_f32 v80, v80, v143, v144
    v_max3_f32 v81, v81, -v143, -v144
    v_max_f32_e64 v80, v80, v145
    v_max_f32_e64 v81, v81, -v145
    v_permlane32_swap_b32_e64 v84, v85
    v_pk_mul_f32 v[236:237], v[236:237], v[84:85]
    v_permlane32_swap_b32 v80, v81
    v_max_f32 v82, v80, v81
    v_mul_f32 v80, s61, v82
    v_mul_f32 v81, s61, v82
    v_pk_mul_f32 v[238:239], v[238:239], v[84:85]
    v_pk_mul_f32 v[240:241], v[240:241], v[84:85]
    v_permlane32_swap_b32_e64 v80, v81
    v_cvt_pk_bf16_f32 v88, v236, v237
    v_pk_mul_f32 v[242:243], v[242:243], v[84:85]
    v_cvt_pk_bf16_f32 v89, v238, v239
    v_pk_mul_f32 v[244:245], v[244:245], v[84:85]
    v_cvt_pk_bf16_f32 v90, v240, v241
    v_pk_mul_f32 v[246:247], v[246:247], v[84:85]
    v_cvt_pk_bf16_f32 v91, v242, v243
    v_pk_mul_f32 v[248:249], v[248:249], v[84:85]
    v_cvt_pk_bf16_f32 v92, v244, v245
    v_pk_mul_f32 v[250:251], v[250:251], v[84:85]
    v_cvt_pk_bf16_f32 v93, v246, v247
    v_pk_mul_f32 v[252:253], v[252:253], v[84:85]
    v_cvt_pk_bf16_f32 v94, v248, v249
    v_pk_mul_f32 v[254:255], v[254:255], v[84:85]
    v_cvt_pk_bf16_f32 v95, v250, v251
    v_cvt_pk_bf16_f32 v96, v252, v253
    v_cvt_pk_bf16_f32 v97, v254, v255
    v_pk_fma_f32 v[236:237], v[136:137], s[60:61], v[80:81] op_sel:[0,0,0] op_sel_hi:[0,1,1]
    v_pk_fma_f32 v[238:239], v[136:137], s[60:61], v[80:81] op_sel:[1,0,0] op_sel_hi:[1,1,1]
    v_pk_fma_f32 v[240:241], v[138:139], s[60:61], v[80:81] op_sel:[0,0,0] op_sel_hi:[0,1,1]
    v_pk_fma_f32 v[242:243], v[138:139], s[60:61], v[80:81] op_sel:[1,0,0] op_sel_hi:[1,1,1]
    v_pk_fma_f32 v[244:245], v[140:141], s[60:61], v[80:81] op_sel:[0,0,0] op_sel_hi:[0,1,1]
    v_pk_fma_f32 v[246:247], v[140:141], s[60:61], v[80:81] op_sel:[1,0,0] op_sel_hi:[1,1,1]
    v_pk_fma_f32 v[248:249], v[142:143], s[60:61], v[80:81] op_sel:[0,0,0] op_sel_hi:[0,1,1]
    v_pk_fma_f32 v[250:251], v[142:143], s[60:61], v[80:81] op_sel:[1,0,0] op_sel_hi:[1,1,1]
    v_pk_fma_f32 v[252:253], v[144:145], s[60:61], v[80:81] op_sel:[0,0,0] op_sel_hi:[0,1,1]
    v_pk_fma_f32 v[254:255], v[144:145], s[60:61], v[80:81] op_sel:[1,0,0] op_sel_hi:[1,1,1]
    v_exp_f32 v236, v236
    v_exp_f32 v237, v237
    v_exp_f32 v238, v238
    v_exp_f32 v239, v239
    v_exp_f32 v240, v240
    v_exp_f32 v241, v241
    v_exp_f32 v242, v242
    v_exp_f32 v243, v243
    v_exp_f32 v244, v244
    v_exp_f32 v245, v245
    v_exp_f32 v246, v246
    v_exp_f32 v247, v247
    v_exp_f32 v248, v248
    v_exp_f32 v249, v249
    v_exp_f32 v250, v250
    v_exp_f32 v251, v251
    v_exp_f32 v252, v252
    v_exp_f32 v253, v253
    v_exp_f32 v254, v254
    v_exp_f32 v255, v255
    v_pk_add_f32 v[82:83], v[236:237], v[238:239]
    v_pk_add_f32 v[80:81], v[240:241], v[242:243]
    v_pk_add_f32 v[82:83], v[82:83], v[244:245]
    v_pk_add_f32 v[80:81], v[80:81], v[246:247]
    v_pk_add_f32 v[82:83], v[82:83], v[248:249]
    v_pk_add_f32 v[80:81], v[80:81], v[250:251]
    v_pk_add_f32 v[82:83], v[82:83], v[252:253]
    v_pk_add_f32 v[80:81], v[80:81], v[254:255]
    v_pk_add_f32 v[82:83], v[82:83], v[80:81]
    v_max3_f32 v84, v168, v169, v170
    v_max3_f32 v85, -v168, -v169, -v170
    v_permlane32_swap_b32 v82, v83
    v_add_f32 v82, v82, v83
    v_max3_f32 v84, v84, v171, v172
    v_max3_f32 v85, v85, -v171, -v172
    v_rcp_f32_e64 v80, v82
    v_max3_f32 v84, v84, v173, v174
    v_max3_f32 v85, v85, -v173, -v174
    v_mov_b32_e64 v81, v80
    v_max3_f32 v84, v84, v175, v176
    v_max3_f32 v85, v85, -v175, -v176
    v_max_f32_e64 v84, v84, v177
    v_max_f32_e64 v85, v85, -v177
    v_permlane32_swap_b32_e64 v80, v81
    v_pk_mul_f32 v[236:237], v[236:237], v[80:81]
    v_permlane32_swap_b32 v84, v85
    v_max_f32 v86, v84, v85
    v_mul_f32 v84, s61, v86
    v_mul_f32 v85, s61, v86
    v_pk_mul_f32 v[238:239], v[238:239], v[80:81]
    v_pk_mul_f32 v[240:241], v[240:241], v[80:81]
    v_permlane32_swap_b32_e64 v84, v85
    v_cvt_pk_bf16_f32 v120, v236, v237
    v_pk_mul_f32 v[242:243], v[242:243], v[80:81]
    v_cvt_pk_bf16_f32 v121, v238, v239
    v_pk_mul_f32 v[244:245], v[244:245], v[80:81]
    v_cvt_pk_bf16_f32 v122, v240, v241
    v_pk_mul_f32 v[246:247], v[246:247], v[80:81]
    v_cvt_pk_bf16_f32 v123, v242, v243
    v_pk_mul_f32 v[248:249], v[248:249], v[80:81]
    v_cvt_pk_bf16_f32 v124, v244, v245
    v_pk_mul_f32 v[250:251], v[250:251], v[80:81]
    v_cvt_pk_bf16_f32 v125, v246, v247
    v_pk_mul_f32 v[252:253], v[252:253], v[80:81]
    v_cvt_pk_bf16_f32 v126, v248, v249
    v_pk_mul_f32 v[254:255], v[254:255], v[80:81]
    v_cvt_pk_bf16_f32 v127, v250, v251
    v_cvt_pk_bf16_f32 v128, v252, v253
    v_cvt_pk_bf16_f32 v129, v254, v255
    v_pk_fma_f32 v[236:237], v[168:169], s[60:61], v[84:85] op_sel:[0,0,0] op_sel_hi:[0,1,1]
    v_pk_fma_f32 v[238:239], v[168:169], s[60:61], v[84:85] op_sel:[1,0,0] op_sel_hi:[1,1,1]
    v_pk_fma_f32 v[240:241], v[170:171], s[60:61], v[84:85] op_sel:[0,0,0] op_sel_hi:[0,1,1]
    v_pk_fma_f32 v[242:243], v[170:171], s[60:61], v[84:85] op_sel:[1,0,0] op_sel_hi:[1,1,1]
    v_pk_fma_f32 v[244:245], v[172:173], s[60:61], v[84:85] op_sel:[0,0,0] op_sel_hi:[0,1,1]
    v_pk_fma_f32 v[246:247], v[172:173], s[60:61], v[84:85] op_sel:[1,0,0] op_sel_hi:[1,1,1]
    v_pk_fma_f32 v[248:249], v[174:175], s[60:61], v[84:85] op_sel:[0,0,0] op_sel_hi:[0,1,1]
    v_pk_fma_f32 v[250:251], v[174:175], s[60:61], v[84:85] op_sel:[1,0,0] op_sel_hi:[1,1,1]
    v_pk_fma_f32 v[252:253], v[176:177], s[60:61], v[84:85] op_sel:[0,0,0] op_sel_hi:[0,1,1]
    v_pk_fma_f32 v[254:255], v[176:177], s[60:61], v[84:85] op_sel:[1,0,0] op_sel_hi:[1,1,1]
    v_exp_f32 v236, v236
    v_exp_f32 v237, v237
    v_exp_f32 v238, v238
    v_exp_f32 v239, v239
    v_exp_f32 v240, v240
    v_exp_f32 v241, v241
    v_exp_f32 v242, v242
    v_exp_f32 v243, v243
    v_exp_f32 v244, v244
    v_exp_f32 v245, v245
    v_exp_f32 v246, v246
    v_exp_f32 v247, v247
    v_exp_f32 v248, v248
    v_exp_f32 v249, v249
    v_exp_f32 v250, v250
    v_exp_f32 v251, v251
    v_exp_f32 v252, v252
    v_exp_f32 v253, v253
    v_exp_f32 v254, v254
    v_exp_f32 v255, v255
    v_pk_add_f32 v[86:87], v[236:237], v[238:239]
    v_pk_add_f32 v[84:85], v[240:241], v[242:243]
    v_pk_add_f32 v[86:87], v[86:87], v[244:245]
    v_pk_add_f32 v[84:85], v[84:85], v[246:247]
    v_pk_add_f32 v[86:87], v[86:87], v[248:249]
    v_pk_add_f32 v[84:85], v[84:85], v[250:251]
    v_pk_add_f32 v[86:87], v[86:87], v[252:253]
    v_pk_add_f32 v[84:85], v[84:85], v[254:255]
    v_pk_add_f32 v[86:87], v[86:87], v[84:85]
    s_nop 1
    v_permlane32_swap_b32 v86, v87
    v_add_f32 v86, v86, v87
    v_rcp_f32 v84, v86
    s_nop 0
    v_mov_b32 v85, v84
    s_nop 1
    v_permlane32_swap_b32 v84, v85
    v_pk_mul_f32 v[236:237], v[236:237], v[84:85]
    v_pk_mul_f32 v[238:239], v[238:239], v[84:85]
    v_pk_mul_f32 v[240:241], v[240:241], v[84:85]
    v_cvt_pk_bf16_f32 v152, v236, v237
    v_pk_mul_f32 v[242:243], v[242:243], v[84:85]
    v_cvt_pk_bf16_f32 v153, v238, v239
    v_pk_mul_f32 v[244:245], v[244:245], v[84:85]
    v_cvt_pk_bf16_f32 v154, v240, v241
    v_pk_mul_f32 v[246:247], v[246:247], v[84:85]
    v_cvt_pk_bf16_f32 v155, v242, v243
    v_pk_mul_f32 v[248:249], v[248:249], v[84:85]
    v_cvt_pk_bf16_f32 v156, v244, v245
    v_pk_mul_f32 v[250:251], v[250:251], v[84:85]
    v_cvt_pk_bf16_f32 v157, v246, v247
    v_pk_mul_f32 v[252:253], v[252:253], v[84:85]
    v_cvt_pk_bf16_f32 v158, v248, v249
    v_pk_mul_f32 v[254:255], v[254:255], v[84:85]
    v_cvt_pk_bf16_f32 v159, v250, v251
    v_cvt_pk_bf16_f32 v160, v252, v253
    v_cvt_pk_bf16_f32 v161, v254, v255
    v_and_b32 v8, 31, v1
    v_max_u32 v8, 8, v8
    v_lshrrev_b32 v9, 5, v1
    v_mul_u32_u24 v9, 24, v9
    v_add3_u32 v8, v8, v9, -8
    s_mul_i32 s50, s53, 1920
    s_add_u32 s50, s50, 20480
    v_lshl_add_u32 v9, v8, 3, s50
    v_lshl_add_u32 v8, v8, 4, s50
    v_mov_b32 v30, 0
    v_mov_b32_e64 v31, 0
    s_lshr_b32 s50, s54, 2
    s_mul_i32 s50, s50, 5120
    s_mul_i32 s56, s55, 40960
    s_add_u32 s56, s56, s50
    s_and_b32 s50, s54, 3
    s_lshl_b32 s51, s50, 10
    v_lshl_add_u32 v10, v1, 4, s51
    s_lshl_b32 s51, s50, 8
    s_add_u32 s51, s51, 4096
    v_lshl_add_u32 v11, v1, 2, s51
    s_barrier
    s_nop 0
    ds_read_b128 v[20:23], v8
    ds_read_b128 v[24:27], v8 offset:768
    ds_read_b64 v[28:29], v9 offset:1536
    s_waitcnt lgkmcnt(0)
    s_nop 0
    v_mfma_f32_32x32x16_bf16 v[104:119], v[20:23], v[88:91], 0
    v_mfma_f32_32x32x16_bf16 v[104:119], v[24:27], v[92:95], v[104:119]
    v_mfma_f32_32x32x16_bf16 v[104:119], v[28:31], v[96:99], v[104:119]
    v_mfma_f32_32x32x16_bf16 v[136:151], v[20:23], v[120:123], 0
    s_nop 5
    v_mfma_f32_32x32x16_bf16 v[136:151], v[24:27], v[124:127], v[136:151]
    s_nop 2
    v_mfma_f32_32x32x16_bf16 v[136:151], v[28:31], v[128:131], v[136:151]
    v_add_f32 v80, 0x358637bd, v118
    v_rcp_f32 v80, v80
    s_nop 0
    v_mul_f32 v108, v108, v80
    v_mul_f32 v109, v109, v80
    v_mul_f32 v110, v110, v80
    v_mul_f32 v111, v111, v80
    v_mfma_f32_32x32x16_bf16 v[168:183], v[20:23], v[152:155], 0
    v_mul_f32 v112, v112, v80
    v_mul_f32 v113, v113, v80
    v_mul_f32 v114, v114, v80
    v_mul_f32 v115, v115, v80
    v_mul_f32 v116, v116, v80
    v_mul_f32 v117, v117, v80
    v_mfma_f32_32x32x16_bf16 v[168:183], v[24:27], v[156:159], v[168:183]
    v_cvt_pk_bf16_f32 v48, v108, v109
    v_cvt_pk_bf16_f32 v49, v110, v111
    v_cvt_pk_bf16_f32 v50, v112, v113
    v_cvt_pk_bf16_f32 v51, v114, v115
    v_cvt_pk_bf16_f32 v52, v116, v117
    buffer_store_dwordx4 v[48:51], v10, s[44:47], s56 offen sc1
    v_mfma_f32_32x32x16_bf16 v[168:183], v[28:31], v[160:163], v[168:183]
    buffer_store_dword v52, v11, s[44:47], s56 offen sc1
    s_add_u32 s56, s56, 40960
    v_add_f32 v80, 0x358637bd, v150
    v_rcp_f32 v80, v80
    s_nop 0
    v_mul_f32 v140, v140, v80
    v_mul_f32 v141, v141, v80
    v_mul_f32 v142, v142, v80
    v_mul_f32 v143, v143, v80
    v_mul_f32 v144, v144, v80
    v_mul_f32 v145, v145, v80
    v_mul_f32 v146, v146, v80
    v_mul_f32 v147, v147, v80
    v_mul_f32 v148, v148, v80
    v_mul_f32 v149, v149, v80
    v_cvt_pk_bf16_f32 v56, v140, v141
    v_cvt_pk_bf16_f32 v57, v142, v143
    v_cvt_pk_bf16_f32 v58, v144, v145
    v_cvt_pk_bf16_f32 v59, v146, v147
    v_cvt_pk_bf16_f32 v60, v148, v149
    buffer_store_dwordx4 v[56:59], v10, s[44:47], s56 offen sc1
    buffer_store_dword v60, v11, s[44:47], s56 offen sc1
    s_add_u32 s56, s56, 40960
    v_add_f32 v80, 0x358637bd, v182
    v_rcp_f32 v80, v80
    s_nop 0
    v_pk_mul_f32 v[172:173], v[172:173], v[80:81] op_sel_hi:[1,0]
    v_pk_mul_f32 v[174:175], v[174:175], v[80:81] op_sel_hi:[1,0]
    v_pk_mul_f32 v[176:177], v[176:177], v[80:81] op_sel_hi:[1,0]
    v_pk_mul_f32 v[178:179], v[178:179], v[80:81] op_sel_hi:[1,0]
    v_pk_mul_f32 v[180:181], v[180:181], v[80:81] op_sel_hi:[1,0]
    v_cvt_pk_bf16_f32 v64, v172, v173
    v_cvt_pk_bf16_f32 v65, v174, v175
    v_cvt_pk_bf16_f32 v66, v176, v177
    v_cvt_pk_bf16_f32 v67, v178, v179
    v_cvt_pk_bf16_f32 v68, v180, v181
    buffer_store_dwordx4 v[64:67], v10, s[44:47], s56 offen sc1
    buffer_store_dword v68, v11, s[44:47], s56 offen sc1
    s_add_u32 s56, s56, 40960
    s_lshl_b32 s50, s7, 11
    s_lshl_b32 s51, s3, 7
    s_add_u32 s50, s50, s51
    s_add_u32 s50, s50, 2048
    v_mov_b32 v6, s50
    v_mov_b32_e64 v7, 1
    s_mul_i32 s66, s48, 86
    s_lshr_b32 s66, s66, 8
    s_lshl_b32 s66, s66, 11
    s_add_u32 s66, s66, 2048
    s_lshl_b32 s8, s48, 1
    s_add_u32 s8, s8, s5
    s_lshr_b32 s9, s49, 1
    s_mul_i32 s9, s9, 0
    s_add_u32 s8, s8, s9
    s_mul_i32 s51, s53, 2560
    s_mul_i32 s56, s48, 81920
    v_lshlrev_b32_e64 v4, 4, v1
    s_and_b32 s57, s49, 0
    s_mul_i32 s57, s57, 40960
    s_add_u32 s56, s56, s57
    s_lshl_b32 s57, s57, 1
    s_sub_u32 s57, 40960, s57
    s_add_u32 s50, s52, 0
    s_add_u32 s9, s50, s8
    s_and_b32 s9, s9, 7
    s_mul_i32 s9, s9, 5120
    s_mul_i32 s50, s50, 5120
    s_add_u32 s9, s9, s56
    s_add_u32 s24, s9, s51
    s_add_u32 s29, s50, 79872
    s_add_u32 s29, s29, s51
    s_add_u32 s50, s52, 2
    s_add_u32 s9, s50, s8
    s_and_b32 s9, s9, 7
    s_mul_i32 s9, s9, 5120
    s_mul_i32 s50, s50, 5120
    s_add_u32 s9, s9, s56
    s_add_u32 s25, s9, s51
    s_add_u32 s30, s50, 79872
    s_add_u32 s30, s30, s51
    s_add_u32 s50, s4, 4
    s_add_u32 s9, s50, s8
    s_and_b32 s9, s9, 7
    s_mul_i32 s9, s9, 5120
    s_mul_i32 s50, s50, 5120
    s_add_u32 s9, s9, s56
    s_add_u32 s26, s9, 0
    s_add_u32 s31, s50, 79872
    s_add_u32 s50, s4, 0
    s_add_u32 s9, s50, s8
    s_and_b32 s9, s9, 7
    s_mul_i32 s9, s9, 5120
    s_mul_i32 s50, s50, 5120
    s_add_u32 s9, s9, s56
    s_add_u32 s27, s9, s57
    s_add_u32 s32, s50, 120832
    s_add_u32 s50, s4, 4
    s_add_u32 s9, s50, s8
    s_and_b32 s9, s9, 7
    s_mul_i32 s9, s9, 5120
    s_mul_i32 s50, s50, 5120
    s_add_u32 s9, s9, s56
    s_add_u32 s28, s9, s57
    s_add_u32 s33, s50, 120832
    s_waitcnt vmcnt(0)
    s_barrier
    s_cmp_lg_u32 s4, 1
    s_cbranch_scc1 B_NOFLAG2
    s_mov_b64 exec, 1
    buffer_store_dword v7, v6, s[40:43], 0 offen sc1
    s_mov_b64 exec, -1
B_NOFLAG2:
    s_cmp_ge_u32 s6, 20
    s_cbranch_scc1 B_EXIT
    s_cmp_lg_u32 s4, 0
    s_cbranch_scc1 B_NOPOLL2
    v_lshlrev_b32 v2, 7, v1
    s_mov_b64 exec, 0xffff
    s_mov_b32 s62, 0
B_POLL2:
    s_add_u32 s62, s62, 1
    s_cmp_gt_u32 s62, 200000
    s_cbranch_scc1 B_POLL2_X
    v_mov_b32 v3, 0
    buffer_atomic_or v3, v2, s[40:43], s66 offen sc0 sc1
    s_waitcnt vmcnt(0)
    v_cmp_ne_u32_e64 vcc, 1, v3
    s_cbranch_vccnz B_POLL2
B_POLL2_Y:
B_POLL2_X:
    s_mov_b64 exec, -1
B_NOPOLL2:
    s_barrier
PG_B3:
    s_cbranch_execz PG_B4
    s_nop 0
    s_mov_b32 m0, s29
    s_nop 0
    buffer_load_dwordx4 v4, s[44:47], s24 offen offset:0 sc1 lds
    buffer_load_dwordx4 v4, s[44:47], s24 offen offset:1024 sc1 lds
    s_mov_b32 exec_hi, 0
    buffer_load_dwordx4 v4, s[44:47], s24 offen offset:2048 sc1 lds
    s_mov_b64 exec, -1
    s_mov_b32 m0, s30
    s_nop 0
    buffer_load_dwordx4 v4, s[44:47], s25 offen offset:0 sc1 lds
    buffer_load_dwordx4 v4, s[44:47], s25 offen offset:1024 sc1 lds
    s_mov_b32 exec_hi, 0
    buffer_load_dwordx4 v4, s[44:47], s25 offen offset:2048 sc1 lds
    s_mov_b64 exec, -1
    s_add_u32 m0, s31, 0
    s_add_u32 s50, s26, 0
    buffer_load_dwordx4 v4, s[44:47], s50 offen offset:0 sc1 lds
    buffer_load_dwordx4 v4, s[44:47], s50 offen offset:1024 sc1 lds
    buffer_load_dwordx4 v4, s[44:47], s50 offen offset:2048 sc1 lds
    buffer_load_dwordx4 v4, s[44:47], s50 offen offset:3072 sc1 lds
    s_add_u32 m0, s31, 4096
    s_add_u32 s50, s26, 4096
    buffer_load_dwordx4 v4, s[44:47], s50 offen offset:0 sc1 lds
    s_waitcnt vmcnt(8)
    s_barrier
    s_waitcnt vmcnt(5)
    s_barrier
    s_add_u32 m0, s32, 0
    s_add_u32 s50, s27, 0
    buffer_load_dwordx4 v4, s[44:47], s50 offen offset:0 sc1 lds
    buffer_load_dwordx4 v4, s[44:47], s50 offen offset:1024 sc1 lds
    buffer_load_dwordx4 v4, s[44:47], s50 offen offset:2048 sc1 lds
    buffer_load_dwordx4 v4, s[44:47], s50 offen offset:3072 sc1 lds
    s_add_u32 m0, s32, 4096
    s_add_u32 s50, s27, 4096
    buffer_load_dwordx4 v4, s[44:47], s50 offen offset:0 sc1 lds
    s_waitcnt vmcnt(5)
    s_barrier
    s_add_u32 m0, s33, 0
    s_add_u32 s50, s28, 0
    buffer_load_dwordx4 v4, s[44:47], s50 offen offset:0 sc1 lds
    buffer_load_dwordx4 v4, s[44:47], s50 offen offset:1024 sc1 lds
    buffer_load_dwordx4 v4, s[44:47], s50 offen offset:2048 sc1 lds
    buffer_load_dwordx4 v4, s[44:47], s50 offen offset:3072 sc1 lds
    s_add_u32 m0, s33, 4096
    s_add_u32 s50, s28, 4096
    buffer_load_dwordx4 v4, s[44:47], s50 offen offset:0 sc1 lds
    s_waitcnt vmcnt(5)
    s_barrier
    s_waitcnt vmcnt(0)
    s_barrier
    s_branch B_EXIT
B_LOAD:
    s_sub_u32 s52, s4, 4
    s_cmp_eq_u32 s52, 3
    s_cbranch_scc1 B_WLOAD
    v_lshrrev_b32_e64 v2, 3, v1
    v_mul_u32_u24 v2, 1280, v2
    v_and_b32 v3, 7, v1
    v_lshrrev_b32 v4, 4, v1
    v_xor_b32_e64 v3, v3, v4
    v_lshl_add_u32 v8, v3, 4, v2
    v_xor_b32_e64 v3, 4, v3
    v_lshl_add_u32 v3, v3, 4, v2
    v_add_u32 v9, 9216, v3
    v_add_u32 v10, 18432, v8
    v_add_u32 v11, 18432, v9
    s_mul_i32 s53, s7, 245760
    s_mul_i32 s50, s52, 81920
    s_add_u32 s53, s53, s50
    s_lshl_b32 s55, s52, 13
    s_mul_i32 s50, s59, 128
    s_add_u32 s53, s53, s50
    s_waitcnt lgkmcnt(0)
    s_mov_b64 s[28:29], s[12:13]
    s_mov_b64 s[40:41], s[22:23]
    s_mov_b32 s24, s10
    s_mov_b32 s25, s11
    s_mov_b32 s26, 2621440
    s_mov_b32 s27, 0x20000
    s_barrier
    s_mov_b32 m0, s55
    s_add_u32 s51, s53, 40960
    buffer_load_dwordx4 v8, s[24:27], s53 offen offset:0 lds
    v_lshrrev_b32_e64 v2, 2, v1
    v_mul_u32_u24 v2, 1280, v2
    v_and_b32_e64 v3, 3, v1
    v_lshl_add_u32 v12, v3, 4, v2
    s_lshl_b32 s57, s49, 8
    s_lshl_b32 s50, s52, 6
    s_add_u32 s57, s57, s50
    s_nop 0
    s_mul_i32 s65, s52, 5120
    s_add_u32 s65, s65, 79872
    v_bfe_u32 v2, v1, 2, 2
    v_lshrrev_b32_e64 v4, 5, v1
    v_bfe_u32 v5, v1, 4, 1
    v_and_b32 v6, 1, v3
    v_lshlrev_b32 v6, 5, v6
    v_lshrrev_b32_e64 v7, 1, v3
    v_lshl_add_u32 v7, v5, 1, v7
    v_lshl_add_u32 v6, v7, 3, v6
    v_add_u32_e64 v6, s65, v6
    v_lshl_add_u32 v7, v4, 2, v2
    v_lshl_add_u32 v60, v7, 6, v6
    v_lshrrev_b32 v7, 1, v2
    v_lshlrev_b32 v7, 2, v7
    v_and_b32 v2, 1, v2
    v_add_u32 v7, v7, v2
    v_lshl_add_u32 v7, v4, 1, v7
    v_add_u32_e64 v7, 16, v7
    v_lshl_add_u32 v61, v7, 6, v6
    v_add_u32 v62, 40960, v60
    v_add_u32 v63, 40960, v61
    s_and_b32 s62, s52, 1
    s_mul_i32 s50, s62, 5120
    v_lshl_add_u32 v246, v1, 4, s50
    v_and_b32 v3, 31, v1
    v_mul_u32_u24_e64 v4, 24, v4
    v_add3_u32 v4, v4, v3, -8
    v_lshlrev_b32 v247, 3, v4
    v_lshlrev_b32 v248, 4, v4
    s_mul_i32 s50, s62, 11
    s_add_u32 s50, s50, s7
    s_lshl_b32 s50, s50, 2
    v_mov_b32 v249, s50
    v_mov_b32 v250, 1
    s_lshr_b32 s50, s52, 1
    s_mul_i32 s50, s50, 960
    s_mul_i32 s63, s62, 1920
    s_add_u32 s50, s50, s63
    s_add_u32 s50, s50, 20480
    v_min_u32 v4, 59, v1
    v_lshlrev_b32 v251, 4, v4
    v_add_u32 v252, s50, v251
    v_mov_b32 v253, 0x3f80
    v_mov_b32 v254, 0x3f800000
    v_mov_b32 v224, 0
    v_mov_b32 v225, 0
    v_mov_b32 v226, 0
    v_mov_b32 v227, 0
    v_mov_b32 v228, 0
    v_mov_b32 v229, 0
    v_mov_b32 v230, 0
    v_mov_b32_e64 v231, 0
    s_lshl_b32 s50, s3, 1
    s_add_u32 s50, s50, s62
    s_mul_i32 s50, s50, 11
    s_add_u32 s50, s50, s7
    s_mul_i32 s50, s50, 1920
    s_add_u32 s50, s50, 786432
    v_lshl_add_u32 v4, v1, 7, s50
    s_lshl_b32 s50, s3, 7
    s_add_u32 s50, s50, 40960
    v_cmp_gt_u32 vcc, 15, v1
    v_mov_b32 v5, s50
    s_nop 0
    v_cndmask_b32 v255, v5, v4, vcc
    s_barrier
    buffer_load_dwordx4 v9, s[24:27], s53 offen offset:1024 lds
    buffer_load_dwordx4 v10, s[24:27], s53 offen offset:2048 lds
    buffer_load_dwordx4 v11, s[24:27], s53 offen offset:3072 lds
    s_add_u32 m0, s55, 4096
    s_nop 0
    s_nop 0
    buffer_load_dwordx4 v8, s[24:27], s51 offen offset:0 lds
    buffer_load_dwordx4 v9, s[24:27], s51 offen offset:1024 lds
    buffer_load_dwordx4 v10, s[24:27], s51 offen offset:2048 lds
    buffer_load_dwordx4 v11, s[24:27], s51 offen offset:3072 lds
    s_add_u32 s59, s59, 1
    s_cmp_eq_u32 s59, 10
    s_cselect_b32 s50, 1280, 0
    s_sub_u32 s53, s53, s50
    s_add_u32 s53, s53, 128
    s_barrier
    s_mov_b32 s56, 1
B_XL:
    s_add_u32 s55, s55, 39936
    s_sub_u32 s50, s55, 159744
    s_cselect_b32 s55, s55, s50
    s_mov_b32 m0, s55
    s_nop 0
    s_add_u32 s51, s53, 40960
    buffer_load_dwordx4 v8, s[24:27], s53 offen offset:0 lds
    buffer_load_dwordx4 v9, s[24:27], s53 offen offset:1024 lds
    buffer_load_dwordx4 v10, s[24:27], s53 offen offset:2048 lds
    buffer_load_dwordx4 v11, s[24:27], s53 offen offset:3072 lds
    s_add_u32 m0, s55, 4096
    s_nop 0
    s_nop 0
    buffer_load_dwordx4 v8, s[24:27], s51 offen offset:0 lds
    buffer_load_dwordx4 v9, s[24:27], s51 offen offset:1024 lds
    buffer_load_dwordx4 v10, s[24:27], s51 offen offset:2048 lds
    buffer_load_dwordx4 v11, s[24:27], s51 offen offset:3072 lds
    s_waitcnt vmcnt(8)
    s_barrier
    s_add_u32 s59, s59, 1
    s_cmp_eq_u32 s59, 10
    s_cselect_b32 s50, 1280, 0
    s_sub_u32 s53, s53, s50
    s_add_u32 s53, s53, 128
    s_add_u32 s56, s56, 1
    s_cmp_lt_u32 s56, 10
    s_cbranch_scc1 B_XL
    s_branch B_LJOIN
B_WLOAD:
    v_add_u32 v4, 0, v1
    v_mul_u32_u24 v5, 205, v4
    v_lshrrev_b32 v5, 10, v5
    v_mul_u32_u24 v6, 5, v5
    v_sub_u32 v4, v4, v6
    v_lshlrev_b32 v4, 4, v4
    v_lshrrev_b32_e64 v6, 3, v5
    v_mul_u32_u24 v6, 1280, v6
    v_add_u32_e64 v4, v4, v6
    v_bfe_u32 v6, v5, 1, 2
    v_and_b32_e64 v5, 1, v5
    v_lshl_add_u32 v5, v5, 2, v6
    v_mul_u32_u24 v5, 3840, v5
    v_add_u32 v10, v4, v5
    v_add_u32 v4, 64, v1
    v_mul_u32_u24 v5, 205, v4
    v_lshrrev_b32 v5, 10, v5
    v_mul_u32_u24 v6, 5, v5
    v_sub_u32 v4, v4, v6
    v_lshlrev_b32 v4, 4, v4
    v_lshrrev_b32_e64 v6, 3, v5
    v_mul_u32_u24 v6, 1280, v6
    v_add_u32_e64 v4, v4, v6
    v_bfe_u32 v6, v5, 1, 2
    v_and_b32_e64 v5, 1, v5
    v_lshl_add_u32 v5, v5, 2, v6
    v_mul_u32_u24 v5, 3840, v5
    v_add_u32_e64 v11, v4, v5
    v_subrev_u32 v11, 1024, v11
    s_mul_i32 s53, s3, 153600
    s_add_u32 s53, s53, 1572864
    v_lshlrev_b32_e64 v8, 4, v1
    s_mov_b32 s55, 24576
    s_mul_i32 s50, s59, 15360
    s_add_u32 s53, s53, s50
    s_waitcnt lgkmcnt(0)
    s_mov_b64 s[28:29], s[12:13]
    s_mov_b64 s[40:41], s[22:23]
    s_barrier
    v_lshrrev_b32 v2, 2, v1
    v_mul_u32_u24 v2, 1280, v2
    v_and_b32_e64 v3, 3, v1
    v_lshl_add_u32 v12, v3, 4, v2
    s_lshl_b32 s57, s49, 8
    s_lshl_b32 s50, s52, 6
    s_add_u32 s57, s57, s50
    s_nop 0
    s_mul_i32 s65, s52, 5120
    s_add_u32 s65, s65, 79872
    v_bfe_u32 v2, v1, 2, 2
    v_lshrrev_b32_e64 v4, 5, v1
    v_bfe_u32 v5, v1, 4, 1
    v_and_b32 v6, 1, v3
    v_lshlrev_b32 v6, 5, v6
    v_lshrrev_b32_e64 v7, 1, v3
    v_lshl_add_u32 v7, v5, 1, v7
    v_lshl_add_u32 v6, v7, 3, v6
    v_add_u32_e64 v6, s65, v6
    v_lshl_add_u32 v7, v4, 2, v2
    v_lshl_add_u32 v60, v7, 6, v6
    v_lshrrev_b32 v7, 1, v2
    v_lshlrev_b32 v7, 2, v7
    v_and_b32 v2, 1, v2
    v_add_u32 v7, v7, v2
    v_lshl_add_u32 v7, v4, 1, v7
    v_add_u32_e64 v7, 16, v7
    v_lshl_add_u32 v61, v7, 6, v6
    v_add_u32 v62, 40960, v60
    v_add_u32 v63, 40960, v61
    s_and_b32 s62, s52, 1
    s_mul_i32 s50, s62, 5120
    v_lshl_add_u32 v246, v1, 4, s50
    v_and_b32 v3, 31, v1
    v_mul_u32_u24_e64 v4, 24, v4
    v_add3_u32 v4, v4, v3, -8
    v_lshlrev_b32 v247, 3, v4
    v_lshlrev_b32 v248, 4, v4
    s_mul_i32 s50, s62, 11
    s_add_u32 s50, s50, s7
    s_lshl_b32 s50, s50, 2
    v_mov_b32 v249, s50
    v_mov_b32 v250, 1
    s_lshr_b32 s50, s52, 1
    s_mul_i32 s50, s50, 960
    s_mul_i32 s63, s62, 1920
    s_add_u32 s50, s50, s63
    s_add_u32 s50, s50, 20480
    v_min_u32 v4, 59, v1
    v_lshlrev_b32 v251, 4, v4
    v_add_u32 v252, s50, v251
    v_mov_b32 v253, 0x3f80
    v_mov_b32 v254, 0x3f800000
    v_mov_b32 v224, 0
    v_mov_b32 v225, 0
    v_mov_b32 v226, 0
    v_mov_b32 v227, 0
    v_mov_b32 v228, 0
    v_mov_b32 v229, 0
    v_mov_b32 v230, 0
    v_mov_b32_e64 v231, 0
    s_lshl_b32 s50, s3, 1
    s_add_u32 s50, s50, s62
    s_mul_i32 s50, s50, 11
    s_add_u32 s50, s50, s7
    s_mul_i32 s50, s50, 1920
    s_add_u32 s50, s50, 786432
    v_lshl_add_u32 v4, v1, 7, s50
    s_lshl_b32 s50, s3, 7
    s_add_u32 s50, s50, 40960
    v_cmp_gt_u32 vcc, 15, v1
    v_mov_b32 v5, s50
    s_nop 0
    v_cndmask_b32 v255, v5, v4, vcc
    s_barrier
    v_add_u32_e64 v2, s68, v1
    s_mov_b64 exec, 0x3fffff
    s_mov_b32 s69, 0
    s_mov_b32 s62, 0
B_DIE:
    s_add_u32 s62, s62, 1
    s_cmp_gt_u32 s62, 96
    s_cbranch_scc1 B_DIE_X
    global_load_ubyte v3, v2, s[20:21] sc1
    s_waitcnt vmcnt(0)
    v_cmp_ne_u32 vcc, s67, v3
    s_cbranch_vccnz B_DIE
B_DIE_Y:
    s_mov_b32 s69, 1
B_DIE_X:
    s_mov_b64 exec, -1
    v_mov_b32 v7, s69
    ds_write_b32 v14, v7 offset:8
    s_cmp_eq_u32 s69, 0
    s_cbranch_scc1 B_WDIR0
    s_add_u32 m0, s55, 0
    s_add_u32 s50, s53, 0
    buffer_load_dwordx4 v8, s[40:43], s50 offen offset:0 lds
    buffer_load_dwordx4 v8, s[40:43], s50 offen offset:1024 lds
    buffer_load_dwordx4 v8, s[40:43], s50 offen offset:2048 lds
    buffer_load_dwordx4 v8, s[40:43], s50 offen offset:3072 lds
    s_add_u32 m0, s55, 4096
    s_add_u32 s50, s53, 4096
    buffer_load_dwordx4 v8, s[40:43], s50 offen offset:0 lds
    buffer_load_dwordx4 v8, s[40:43], s50 offen offset:1024 lds
    buffer_load_dwordx4 v8, s[40:43], s50 offen offset:2048 lds
    buffer_load_dwordx4 v8, s[40:43], s50 offen offset:3072 lds
    s_add_u32 m0, s55, 8192
    s_add_u32 s50, s53, 8192
    buffer_load_dwordx4 v8, s[40:43], s50 offen offset:0 lds
    buffer_load_dwordx4 v8, s[40:43], s50 offen offset:1024 lds
    buffer_load_dwordx4 v8, s[40:43], s50 offen offset:2048 lds
    buffer_load_dwordx4 v8, s[40:43], s50 offen offset:3072 lds
    s_add_u32 m0, s55, 12288
    s_add_u32 s50, s53, 12288
    buffer_load_dwordx4 v8, s[40:43], s50 offen offset:0 lds
    buffer_load_dwordx4 v8, s[40:43], s50 offen offset:1024 lds
    buffer_load_dwordx4 v8, s[40:43], s50 offen offset:2048 lds
    s_add_u32 s59, s59, 1
    s_cmp_eq_u32 s59, 10
    s_cselect_b32 s50, 153600, 0
    s_sub_u32 s53, s53, s50
    s_add_u32 s53, s53, 15360
B_WDONE0:
    s_waitcnt lgkmcnt(0)
    s_barrier
    s_mov_b32 s56, 1
B_WL:
    s_add_u32 s55, s55, 39936
    s_sub_u32 s50, s55, 159744
    s_cselect_b32 s55, s55, s50
    s_cmp_eq_u32 s69, 0
    s_cbranch_scc1 B_WDIR
    s_add_u32 m0, s55, 0
    s_add_u32 s50, s53, 0
    s_nop 0
    buffer_load_dwordx4 v8, s[40:43], s50 offen offset:0 lds
    buffer_load_dwordx4 v8, s[40:43], s50 offen offset:1024 lds
    buffer_load_dwordx4 v8, s[40:43], s50 offen offset:2048 lds
    buffer_load_dwordx4 v8, s[40:43], s50 offen offset:3072 lds
    s_add_u32 m0, s55, 4096
    s_add_u32 s50, s53, 4096
    buffer_load_dwordx4 v8, s[40:43], s50 offen offset:0 lds
    buffer_load_dwordx4 v8, s[40:43], s50 offen offset:1024 lds
    buffer_load_dwordx4 v8, s[40:43], s50 offen offset:2048 lds
    buffer_load_dwordx4 v8, s[40:43], s50 offen offset:3072 lds
    s_add_u32 m0, s55, 8192
    s_add_u32 s50, s53, 8192
    buffer_load_dwordx4 v8, s[40:43], s50 offen offset:0 lds
    buffer_load_dwordx4 v8, s[40:43], s50 offen offset:1024 lds
    buffer_load_dwordx4 v8, s[40:43], s50 offen offset:2048 lds
    buffer_load_dwordx4 v8, s[40:43], s50 offen offset:3072 lds
    s_add_u32 m0, s55, 12288
    s_add_u32 s50, s53, 12288
    buffer_load_dwordx4 v8, s[40:43], s50 offen offset:0 lds
    buffer_load_dwordx4 v8, s[40:43], s50 offen offset:1024 lds
    buffer_load_dwordx4 v8, s[40:43], s50 offen offset:2048 lds
    s_waitcnt vmcnt(15)
    s_barrier
    s_add_u32 s59, s59, 1
    s_cmp_eq_u32 s59, 10
    s_cselect_b32 s50, 153600, 0
    s_sub_u32 s53, s53, s50
    s_add_u32 s53, s53, 15360
B_WDONE:
    s_add_u32 s56, s56, 1
    s_cmp_lt_u32 s56, 10
    s_cbranch_scc1 B_WL
B_LJOIN:
    s_mov_b32 s36, s16
    s_mov_b32 s37, s17
    s_mov_b32 s38, 819200
    s_mov_b32 s39, 0x20000
    s_lshl_b32 s8, s48, 1
    s_add_u32 s8, s8, s5
    s_lshr_b32 s9, s49, 1
    s_mul_i32 s9, s9, 0
    s_add_u32 s8, s8, s9
    global_load_dword v13, v15, s[20:21] offset:28 sc1
    buffer_load_dword v59, v255, s[40:43], 0 offen sc1
    s_add_u32 s9, s8, 0
    s_and_b32 s9, s9, 7
    s_mul_i32 s9, s9, 102400
    s_add_u32 s9, s9, s57
    s_add_u32 m0, s65, 0
    s_add_u32 s50, s9, 0
    buffer_load_dwordx4 v12, s[36:39], s50 offen lds
    s_add_u32 m0, s65, 1024
    s_add_u32 s50, s9, 20480
    buffer_load_dwordx4 v12, s[36:39], s50 offen lds
    s_add_u32 m0, s65, 2048
    s_add_u32 s50, s9, 40960
    buffer_load_dwordx4 v12, s[36:39], s50 offen lds
    s_add_u32 m0, s65, 3072
    s_add_u32 s50, s9, 61440
    buffer_load_dwordx4 v12, s[36:39], s50 offen lds
    s_add_u32 m0, s65, 4096
    s_add_u32 s50, s9, 81920
    buffer_load_dwordx4 v12, s[36:39], s50 offen lds
    ds_read_b32 v11, v14 offset:8
    s_and_b32 s53, s52, 1
    s_lshl_b32 s55, s3, 1
    s_add_u32 s55, s55, s53
    s_mul_i32 s51, s55, 11
    s_add_u32 s51, s51, s7
    s_nop 0
    s_mul_i32 s51, s51, 1920
    s_add_u32 s63, s51, 65536
    s_add_u32 s51, s51, 786432
    s_lshl_b32 s66, s3, 7
    s_add_u32 s64, s66, 40960
    s_lshr_b32 s54, s52, 1
    s_mul_i32 s54, s54, 960
    s_mul_i32 s55, s55, 21120
    s_add_u32 s55, s55, s54
    s_add_u32 s55, s55, 65536
    s_mul_i32 s53, s53, 44
    s_add_u32 s53, s53, s66
    s_waitcnt lgkmcnt(0)
    v_readfirstlane_b32 s69, v11
    s_nop 0
    s_cmp_lg_u32 s69, 0
    s_cselect_b32 s50, 720896, 0
    s_cselect_b32 s56, 40960, 0
    s_add_u32 s55, s55, s50
    s_add_u32 s53, s53, s56
    s_waitcnt vmcnt(7)
    s_barrier
    s_setprio 1
    s_add_u32 s9, s8, 1
    s_and_b32 s9, s9, 7
    s_mul_i32 s9, s9, 102400
    s_add_u32 s9, s9, s57
    s_add_u32 m0, s65, 20480
    s_add_u32 s50, s9, 0
    buffer_load_dwordx4 v12, s[36:39], s50 offen lds
    s_add_u32 m0, s65, 21504
    s_add_u32 s50, s9, 20480
    buffer_load_dwordx4 v12, s[36:39], s50 offen lds
    s_add_u32 m0, s65, 22528
    s_add_u32 s50, s9, 40960
    buffer_load_dwordx4 v12, s[36:39], s50 offen lds
    s_add_u32 m0, s65, 23552
    s_add_u32 s50, s9, 61440
    buffer_load_dwordx4 v12, s[36:39], s50 offen lds
    s_add_u32 m0, s65, 24576
    s_add_u32 s50, s9, 81920
    buffer_load_dwordx4 v12, s[36:39], s50 offen lds
    s_add_u32 s9, s8, 2
    s_and_b32 s9, s9, 7
    s_mul_i32 s9, s9, 102400
    s_add_u32 s9, s9, s57
    s_add_u32 m0, s65, 40960
    s_add_u32 s50, s9, 0
    buffer_load_dwordx4 v12, s[36:39], s50 offen lds
    s_add_u32 m0, s65, 41984
    s_add_u32 s50, s9, 20480
    buffer_load_dwordx4 v12, s[36:39], s50 offen lds
    s_add_u32 m0, s65, 43008
    s_add_u32 s50, s9, 40960
    buffer_load_dwordx4 v12, s[36:39], s50 offen lds
    s_add_u32 m0, s65, 44032
    s_add_u32 s50, s9, 61440
    buffer_load_dwordx4 v12, s[36:39], s50 offen lds
    s_add_u32 m0, s65, 45056
    s_add_u32 s50, s9, 81920
    buffer_load_dwordx4 v12, s[36:39], s50 offen lds
    s_add_u32 s9, s8, 3
    s_and_b32 s9, s9, 7
    s_mul_i32 s9, s9, 102400
    s_add_u32 s9, s9, s57
    s_add_u32 m0, s65, 61440
    s_add_u32 s50, s9, 0
    buffer_load_dwordx4 v12, s[36:39], s50 offen lds
    s_add_u32 m0, s65, 62464
    s_add_u32 s50, s9, 20480
    buffer_load_dwordx4 v12, s[36:39], s50 offen lds
    s_add_u32 m0, s65, 63488
    s_add_u32 s50, s9, 40960
    buffer_load_dwordx4 v12, s[36:39], s50 offen lds
    s_add_u32 m0, s65, 64512
    s_add_u32 s50, s9, 61440
    buffer_load_dwordx4 v12, s[36:39], s50 offen lds
    s_add_u32 m0, s65, 65536
    s_add_u32 s50, s9, 81920
    buffer_load_dwordx4 v12, s[36:39], s50 offen lds
    s_waitcnt vmcnt(15)
    s_nop 0
    ds_read_b64_tr_b16 v[64:65], v60 offset:0
    ds_read_b64_tr_b16 v[66:67], v60 offset:512
    ds_read_b64_tr_b16 v[68:69], v60 offset:1536
    ds_read_b64_tr_b16 v[70:71], v60 offset:2048
    ds_read_b64_tr_b16 v[72:73], v60 offset:2560
    ds_read_b64_tr_b16 v[74:75], v60 offset:3072
    ds_read_b64_tr_b16 v[76:77], v60 offset:4096
    ds_read_b64_tr_b16 v[78:79], v60 offset:4608
    ds_read_b64_tr_b16 v[80:81], v61 offset:0
    ds_read_b64_tr_b16 v[82:83], v61 offset:2560
    s_waitcnt lgkmcnt(0)
    s_add_u32 s9, s8, 4
    s_and_b32 s9, s9, 7
    s_mul_i32 s9, s9, 102400
    s_add_u32 s9, s9, s57
    s_add_u32 m0, s65, 0
    s_add_u32 s50, s9, 0
    buffer_load_dwordx4 v12, s[36:39], s50 offen lds
    s_add_u32 m0, s65, 1024
    s_add_u32 s50, s9, 20480
    buffer_load_dwordx4 v12, s[36:39], s50 offen lds
    s_add_u32 m0, s65, 2048
    s_add_u32 s50, s9, 40960
    buffer_load_dwordx4 v12, s[36:39], s50 offen lds
    s_add_u32 m0, s65, 3072
    s_add_u32 s50, s9, 61440
    buffer_load_dwordx4 v12, s[36:39], s50 offen lds
    s_add_u32 m0, s65, 4096
    s_add_u32 s50, s9, 81920
    buffer_load_dwordx4 v12, s[36:39], s50 offen lds
    s_waitcnt vmcnt(15)
    s_nop 0
    ds_read_b64_tr_b16 v[84:85], v60 offset:20480
    ds_read_b64_tr_b16 v[86:87], v60 offset:20992
    ds_read_b64_tr_b16 v[88:89], v60 offset:22016
    ds_read_b64_tr_b16 v[90:91], v60 offset:22528
    ds_read_b64_tr_b16 v[92:93], v60 offset:23040
    ds_read_b64_tr_b16 v[94:95], v60 offset:23552
    ds_read_b64_tr_b16 v[96:97], v60 offset:24576
    ds_read_b64_tr_b16 v[98:99], v60 offset:25088
    ds_read_b64_tr_b16 v[100:101], v61 offset:20480
    ds_read_b64_tr_b16 v[102:103], v61 offset:23040
    s_waitcnt lgkmcnt(0)
    s_add_u32 s9, s8, 5
    s_and_b32 s9, s9, 7
    s_mul_i32 s9, s9, 102400
    s_add_u32 s9, s9, s57
    s_add_u32 m0, s65, 20480
    s_add_u32 s50, s9, 0
    s_nop 0
    buffer_load_dwordx4 v12, s[36:39], s50 offen lds
    s_add_u32 m0, s65, 21504
    s_add_u32 s50, s9, 20480
    buffer_load_dwordx4 v12, s[36:39], s50 offen lds
    s_add_u32 m0, s65, 22528
    s_add_u32 s50, s9, 40960
    buffer_load_dwordx4 v12, s[36:39], s50 offen lds
    s_add_u32 m0, s65, 23552
    s_add_u32 s50, s9, 61440
    buffer_load_dwordx4 v12, s[36:39], s50 offen lds
    s_add_u32 m0, s65, 24576
    s_add_u32 s50, s9, 81920
    buffer_load_dwordx4 v12, s[36:39], s50 offen lds
    s_waitcnt vmcnt(15)
    s_nop 0
    ds_read_b64_tr_b16 v[104:105], v62 offset:0
    ds_read_b64_tr_b16 v[106:107], v62 offset:512
    ds_read_b64_tr_b16 v[108:109], v62 offset:1536
    ds_read_b64_tr_b16 v[110:111], v62 offset:2048
    ds_read_b64_tr_b16 v[112:113], v62 offset:2560
    ds_read_b64_tr_b16 v[114:115], v62 offset:3072
    ds_read_b64_tr_b16 v[116:117], v62 offset:4096
    ds_read_b64_tr_b16 v[118:119], v62 offset:4608
    ds_read_b64_tr_b16 v[120:121], v63 offset:0
    ds_read_b64_tr_b16 v[122:123], v63 offset:2560
    s_waitcnt lgkmcnt(0)
    s_add_u32 s9, s8, 6
    s_and_b32 s9, s9, 7
    s_mul_i32 s9, s9, 102400
    s_add_u32 s9, s9, s57
    s_add_u32 m0, s65, 40960
    s_add_u32 s50, s9, 0
    s_nop 0
    buffer_load_dwordx4 v12, s[36:39], s50 offen lds
    s_add_u32 m0, s65, 41984
    s_add_u32 s50, s9, 20480
    buffer_load_dwordx4 v12, s[36:39], s50 offen lds
    s_add_u32 m0, s65, 43008
    s_add_u32 s50, s9, 40960
    buffer_load_dwordx4 v12, s[36:39], s50 offen lds
    s_add_u32 m0, s65, 44032
    s_add_u32 s50, s9, 61440
    buffer_load_dwordx4 v12, s[36:39], s50 offen lds
    s_add_u32 m0, s65, 45056
    s_add_u32 s50, s9, 81920
    buffer_load_dwordx4 v12, s[36:39], s50 offen lds
    s_waitcnt vmcnt(15)
    s_nop 0
    ds_read_b64_tr_b16 v[124:125], v62 offset:20480
    ds_read_b64_tr_b16 v[126:127], v62 offset:20992
    ds_read_b64_tr_b16 v[128:129], v62 offset:22016
    ds_read_b64_tr_b16 v[130:131], v62 offset:22528
    ds_read_b64_tr_b16 v[132:133], v62 offset:23040
    ds_read_b64_tr_b16 v[134:135], v62 offset:23552
    ds_read_b64_tr_b16 v[136:137], v62 offset:24576
    ds_read_b64_tr_b16 v[138:139], v62 offset:25088
    ds_read_b64_tr_b16 v[140:141], v63 offset:20480
    ds_read_b64_tr_b16 v[142:143], v63 offset:23040
    s_waitcnt lgkmcnt(0)
    s_add_u32 s9, s8, 7
    s_and_b32 s9, s9, 7
    s_mul_i32 s9, s9, 102400
    s_add_u32 s9, s9, s57
    s_add_u32 m0, s65, 61440
    s_add_u32 s50, s9, 0
    s_nop 0
    buffer_load_dwordx4 v12, s[36:39], s50 offen lds
    s_add_u32 m0, s65, 62464
    s_add_u32 s50, s9, 20480
    buffer_load_dwordx4 v12, s[36:39], s50 offen lds
    s_add_u32 m0, s65, 63488
    s_add_u32 s50, s9, 40960
    buffer_load_dwordx4 v12, s[36:39], s50 offen lds
    s_add_u32 m0, s65, 64512
PG_B4:
    s_cbranch_execz PG_B_RET
    s_nop 0
    s_add_u32 s50, s9, 61440
    buffer_load_dwordx4 v12, s[36:39], s50 offen lds
    s_add_u32 m0, s65, 65536
    s_add_u32 s50, s9, 81920
    buffer_load_dwordx4 v12, s[36:39], s50 offen lds
    s_waitcnt vmcnt(15)
    s_nop 0
    ds_read_b64_tr_b16 v[144:145], v60 offset:0
    ds_read_b64_tr_b16 v[146:147], v60 offset:512
    ds_read_b64_tr_b16 v[148:149], v60 offset:1536
    ds_read_b64_tr_b16 v[150:151], v60 offset:2048
    ds_read_b64_tr_b16 v[152:153], v60 offset:2560
    ds_read_b64_tr_b16 v[154:155], v60 offset:3072
    ds_read_b64_tr_b16 v[156:157], v60 offset:4096
    ds_read_b64_tr_b16 v[158:159], v60 offset:4608
    ds_read_b64_tr_b16 v[160:161], v61 offset:0
    ds_read_b64_tr_b16 v[162:163], v61 offset:2560
    s_waitcnt vmcnt(10)
    s_nop 0
    ds_read_b64_tr_b16 v[164:165], v60 offset:20480
    ds_read_b64_tr_b16 v[166:167], v60 offset:20992
    ds_read_b64_tr_b16 v[168:169], v60 offset:22016
    ds_read_b64_tr_b16 v[170:171], v60 offset:22528
    ds_read_b64_tr_b16 v[172:173], v60 offset:23040
    ds_read_b64_tr_b16 v[174:175], v60 offset:23552
    ds_read_b64_tr_b16 v[176:177], v60 offset:24576
    ds_read_b64_tr_b16 v[178:179], v60 offset:25088
    ds_read_b64_tr_b16 v[180:181], v61 offset:20480
    ds_read_b64_tr_b16 v[182:183], v61 offset:23040
    s_waitcnt vmcnt(5)
    s_nop 0
    ds_read_b64_tr_b16 v[184:185], v62 offset:0
    ds_read_b64_tr_b16 v[186:187], v62 offset:512
    ds_read_b64_tr_b16 v[188:189], v62 offset:1536
    ds_read_b64_tr_b16 v[190:191], v62 offset:2048
    ds_read_b64_tr_b16 v[192:193], v62 offset:2560
    ds_read_b64_tr_b16 v[194:195], v62 offset:3072
    ds_read_b64_tr_b16 v[196:197], v62 offset:4096
    ds_read_b64_tr_b16 v[198:199], v62 offset:4608
    ds_read_b64_tr_b16 v[200:201], v63 offset:0
    ds_read_b64_tr_b16 v[202:203], v63 offset:2560
    s_waitcnt vmcnt(0)
    s_nop 0
    ds_read_b64_tr_b16 v[204:205], v62 offset:20480
    ds_read_b64_tr_b16 v[206:207], v62 offset:20992
    ds_read_b64_tr_b16 v[208:209], v62 offset:22016
    ds_read_b64_tr_b16 v[210:211], v62 offset:22528
    ds_read_b64_tr_b16 v[212:213], v62 offset:23040
    ds_read_b64_tr_b16 v[214:215], v62 offset:23552
    ds_read_b64_tr_b16 v[216:217], v62 offset:24576
    ds_read_b64_tr_b16 v[218:219], v62 offset:25088
    ds_read_b64_tr_b16 v[220:221], v63 offset:20480
    ds_read_b64_tr_b16 v[222:223], v63 offset:23040
    s_mov_b32 s62, 0
B_INIT:
    v_cmp_ne_u32_e64 vcc, 0, v13
    s_cbranch_vccnz B_INIT_X
    global_load_dword v13, v15, s[20:21] offset:28 sc1
    s_add_u32 s62, s62, 1
    s_cmp_gt_u32 s62, 200000
    s_waitcnt vmcnt(0)
    s_cbranch_scc0 B_INIT
B_INIT_X:
    s_waitcnt lgkmcnt(0)
    s_barrier
    s_cmp_ge_u32 s52, 2
    s_cbranch_scc1 B_NOPUB
    s_nop 0
    ds_read_b128 v[16:19], v246 offset:0
    ds_read_b128 v[36:39], v246 offset:10240
    ds_read_b128 v[20:23], v246 offset:1024
    ds_read_b128 v[40:43], v246 offset:11264
    ds_read_b128 v[24:27], v246 offset:2048
    ds_read_b128 v[44:47], v246 offset:12288
    ds_read_b128 v[28:31], v246 offset:3072
    ds_read_b128 v[48:51], v246 offset:13312
    ds_read_b128 v[32:35], v246 offset:4096
    ds_read_b128 v[52:55], v246 offset:14336
    s_waitcnt lgkmcnt(8)
    v_add_f32 v16, v16, v36
    v_add_f32 v17, v17, v37
    v_add_f32 v18, v18, v38
    v_add_f32_e64 v19, v19, v39
    v_cvt_pk_bf16_f32 v236, v16, v17
    v_cvt_pk_bf16_f32 v237, v18, v19
    s_waitcnt lgkmcnt(6)
    v_add_f32 v20, v20, v40
    v_add_f32 v21, v21, v41
    v_add_f32 v22, v22, v42
    v_add_f32_e64 v23, v23, v43
    v_cvt_pk_bf16_f32 v238, v20, v21
    v_cvt_pk_bf16_f32 v239, v22, v23
    s_waitcnt lgkmcnt(4)
    v_add_f32 v24, v24, v44
    v_add_f32 v25, v25, v45
    v_add_f32 v26, v26, v46
    v_add_f32_e64 v27, v27, v47
    v_cvt_pk_bf16_f32 v240, v24, v25
    v_cvt_pk_bf16_f32 v241, v26, v27
    s_waitcnt lgkmcnt(2)
    v_add_f32 v28, v28, v48
    v_add_f32 v29, v29, v49
    v_add_f32 v30, v30, v50
    v_add_f32_e64 v31, v31, v51
    v_cvt_pk_bf16_f32 v242, v28, v29
    v_cvt_pk_bf16_f32 v243, v30, v31
    s_waitcnt lgkmcnt(0)
    v_add_f32 v32, v32, v52
    v_add_f32 v33, v33, v53
    v_add_f32 v34, v34, v54
    v_add_f32_e64 v35, v35, v55
    v_cvt_pk_bf16_f32 v244, v32, v33
    v_cvt_pk_bf16_f32 v245, v34, v35
    s_mov_b32 exec_lo, 0xffffff00
    s_mov_b32 exec_hi, 0xffffff00
    buffer_store_dwordx4 v[236:239], v248, s[40:43], s51 offen
    buffer_store_dwordx4 v[240:243], v248, s[40:43], s51 offen offset:768
    buffer_store_dwordx2 v[244:245], v247, s[40:43], s51 offen offset:1536
    s_mov_b64 exec, 1
    s_waitcnt vmcnt(0)
    buffer_store_dword v250, v249, s[40:43], s64 offen
    s_mov_b64 exec, -1
    s_cmp_lg_u32 s69, 0
    s_cbranch_scc1 B_NOPUB
    s_nop 0
    s_mov_b32 exec_lo, 0xffffff00
    s_mov_b32 exec_hi, 0xffffff00
    buffer_store_dwordx4 v[236:239], v248, s[40:43], s63 offen sc1
    buffer_store_dwordx4 v[240:243], v248, s[40:43], s63 offen offset:768 sc1
    buffer_store_dwordx2 v[244:245], v247, s[40:43], s63 offen offset:1536 sc1
    s_mov_b64 exec, 1
    s_waitcnt vmcnt(0)
    buffer_store_dword v250, v249, s[40:43], s66 offen sc1
    s_mov_b64 exec, -1
B_NOPUB:
    v_lshlrev_b32 v2, 2, v1
    s_mov_b64 exec, 0x7ff
    s_mov_b32 s62, 0
B_POLL1:
    s_add_u32 s62, s62, 1
    s_cmp_gt_u32 s62, 200000
    s_cbranch_scc1 B_POLL1_X
    buffer_load_dword v3, v2, s[40:43], s53 offen sc1
    s_waitcnt vmcnt(0)
    v_cmp_ne_u32_e64 vcc, 1, v3
    s_cbranch_vccnz B_POLL1
B_POLL1_Y:
B_POLL1_X:
    s_mov_b64 exec, -1
    buffer_load_dwordx4 v[16:19], v251, s[40:43], s55 offen offset:0 sc1
    buffer_load_dwordx4 v[20:23], v251, s[40:43], s55 offen offset:1920 sc1
    s_add_u32 s55, s55, 3840
    buffer_load_dwordx4 v[24:27], v251, s[40:43], s55 offen offset:0 sc1
    buffer_load_dwordx4 v[28:31], v251, s[40:43], s55 offen offset:1920 sc1
    s_add_u32 s55, s55, 3840
    buffer_load_dwordx4 v[32:35], v251, s[40:43], s55 offen offset:0 sc1
    buffer_load_dwordx4 v[36:39], v251, s[40:43], s55 offen offset:1920 sc1
    s_add_u32 s55, s55, 3840
    buffer_load_dwordx4 v[40:43], v251, s[40:43], s55 offen offset:0 sc1
    buffer_load_dwordx4 v[44:47], v251, s[40:43], s55 offen offset:1920 sc1
    s_add_u32 s55, s55, 3840
    buffer_load_dwordx4 v[48:51], v251, s[40:43], s55 offen offset:0 sc1
    buffer_load_dwordx4 v[52:55], v251, s[40:43], s55 offen offset:1920 sc1
    s_add_u32 s55, s55, 3840
    buffer_load_dwordx4 v[56:59], v251, s[40:43], s55 offen offset:0 sc1
    s_waitcnt vmcnt(10)
    v_dot2c_f32_bf16 v224, v16, v253
    v_dot2c_f32_bf16 v225, v16, v254
    v_dot2c_f32_bf16 v226, v17, v253
    v_dot2c_f32_bf16 v227, v17, v254
    v_dot2c_f32_bf16 v228, v18, v253
    v_dot2c_f32_bf16 v229, v18, v254
    v_dot2c_f32_bf16 v230, v19, v253
    v_dot2c_f32_bf16 v231, v19, v254
    s_waitcnt vmcnt(9)
    v_dot2c_f32_bf16 v224, v20, v253
    v_dot2c_f32_bf16 v225, v20, v254
    v_dot2c_f32_bf16 v226, v21, v253
    v_dot2c_f32_bf16 v227, v21, v254
    v_dot2c_f32_bf16 v228, v22, v253
    v_dot2c_f32_bf16 v229, v22, v254
    v_dot2c_f32_bf16 v230, v23, v253
    v_dot2c_f32_bf16 v231, v23, v254
    s_waitcnt vmcnt(8)
    v_dot2c_f32_bf16 v224, v24, v253
    v_dot2c_f32_bf16 v225, v24, v254
    v_dot2c_f32_bf16 v226, v25, v253
    v_dot2c_f32_bf16 v227, v25, v254
    v_dot2c_f32_bf16 v228, v26, v253
    v_dot2c_f32_bf16 v229, v26, v254
    v_dot2c_f32_bf16 v230, v27, v253
    v_dot2c_f32_bf16 v231, v27, v254
    s_waitcnt vmcnt(7)
    v_dot2c_f32_bf16 v224, v28, v253
    v_dot2c_f32_bf16 v225, v28, v254
    v_dot2c_f32_bf16 v226, v29, v253
    v_dot2c_f32_bf16 v227, v29, v254
    v_dot2c_f32_bf16 v228, v30, v253
    v_dot2c_f32_bf16 v229, v30, v254
    v_dot2c_f32_bf16 v230, v31, v253
    v_dot2c_f32_bf16 v231, v31, v254
    s_waitcnt vmcnt(6)
    v_dot2c_f32_bf16 v224, v32, v253
    v_dot2c_f32_bf16 v225, v32, v254
    v_dot2c_f32_bf16 v226, v33, v253
    v_dot2c_f32_bf16 v227, v33, v254
    v_dot2c_f32_bf16 v228, v34, v253
    v_dot2c_f32_bf16 v229, v34, v254
    v_dot2c_f32_bf16 v230, v35, v253
    v_dot2c_f32_bf16 v231, v35, v254
    s_waitcnt vmcnt(5)
    v_dot2c_f32_bf16 v224, v36, v253
    v_dot2c_f32_bf16 v225, v36, v254
    v_dot2c_f32_bf16 v226, v37, v253
    v_dot2c_f32_bf16 v227, v37, v254
    v_dot2c_f32_bf16 v228, v38, v253
    v_dot2c_f32_bf16 v229, v38, v254
    v_dot2c_f32_bf16 v230, v39, v253
    v_dot2c_f32_bf16 v231, v39, v254
    s_waitcnt vmcnt(4)
    v_dot2c_f32_bf16 v224, v40, v253
    v_dot2c_f32_bf16 v225, v40, v254
    v_dot2c_f32_bf16 v226, v41, v253
    v_dot2c_f32_bf16 v227, v41, v254
    v_dot2c_f32_bf16 v228, v42, v253
    v_dot2c_f32_bf16 v229, v42, v254
    v_dot2c_f32_bf16 v230, v43, v253
    v_dot2c_f32_bf16 v231, v43, v254
    s_waitcnt vmcnt(3)
    v_dot2c_f32_bf16 v224, v44, v253
    v_dot2c_f32_bf16 v225, v44, v254
    v_dot2c_f32_bf16 v226, v45, v253
    v_dot2c_f32_bf16 v227, v45, v254
    v_dot2c_f32_bf16 v228, v46, v253
    v_dot2c_f32_bf16 v229, v46, v254
    v_dot2c_f32_bf16 v230, v47, v253
    v_dot2c_f32_bf16 v231, v47, v254
    s_waitcnt vmcnt(2)
    v_dot2c_f32_bf16 v224, v48, v253
    v_dot2c_f32_bf16 v225, v48, v254
    v_dot2c_f32_bf16 v226, v49, v253
    v_dot2c_f32_bf16 v227, v49, v254
    v_dot2c_f32_bf16 v228, v50, v253
    v_dot2c_f32_bf16 v229, v50, v254
    v_dot2c_f32_bf16 v230, v51, v253
    v_dot2c_f32_bf16 v231, v51, v254
    s_waitcnt vmcnt(1)
    v_dot2c_f32_bf16 v224, v52, v253
    v_dot2c_f32_bf16 v225, v52, v254
    v_dot2c_f32_bf16 v226, v53, v253
    v_dot2c_f32_bf16 v227, v53, v254
    v_dot2c_f32_bf16 v228, v54, v253
    v_dot2c_f32_bf16 v229, v54, v254
    v_dot2c_f32_bf16 v230, v55, v253
    v_dot2c_f32_bf16 v231, v55, v254
    s_waitcnt vmcnt(0)
    v_dot2c_f32_bf16 v224, v56, v253
    v_dot2c_f32_bf16 v225, v56, v254
    v_dot2c_f32_bf16 v226, v57, v253
    v_dot2c_f32_bf16 v227, v57, v254
    v_dot2c_f32_bf16 v228, v58, v253
    v_dot2c_f32_bf16 v229, v58, v254
    v_dot2c_f32_bf16 v230, v59, v253
    v_dot2c_f32_bf16 v231, v59, v254
    s_nop 0
    v_cvt_pk_bf16_f32 v232, v224, v225
    v_cvt_pk_bf16_f32 v233, v226, v227
    v_cvt_pk_bf16_f32 v234, v228, v229
    v_cvt_pk_bf16_f32 v235, v230, v231
    ds_write_b128 v252, v[232:235]
    s_waitcnt lgkmcnt(0)
    s_barrier
    s_setprio 0
    s_cmp_lt_u32 s52, 2
    s_cselect_b32 s50, s69, 0
    s_cmp_eq_u32 s50, 0
    s_cbranch_scc1 B_PUBD
    s_nop 0
    s_mov_b32 exec_lo, 0xffffff00
    s_mov_b32 exec_hi, 0xffffff00
    buffer_store_dwordx4 v[236:239], v248, s[40:43], s63 offen sc1
    buffer_store_dwordx4 v[240:243], v248, s[40:43], s63 offen offset:768 sc1
    buffer_store_dwordx2 v[244:245], v247, s[40:43], s63 offen offset:1536 sc1
    s_mov_b64 exec, 1
    s_barrier
    s_waitcnt vmcnt(0)
    buffer_store_dword v250, v249, s[40:43], s66 offen sc1
    s_mov_b64 exec, -1
    s_branch B_PUBE
B_PUBD:
    s_barrier
B_PUBE:
    s_cmp_ge_u32 s6, 20
    s_cbranch_scc1 B_EXIT
    s_waitcnt lgkmcnt(0)
    s_barrier
    v_lshlrev_b32_e64 v2, 4, v1
    v_add_u32 v2, 79872, v2
    v_add_u32 v3, 40960, v2
    v_lshlrev_b32_e64 v4, 2, v1
    v_add_u32 v4, 83968, v4
    v_add_u32 v5, 40960, v4
    v_and_b32_e64 v6, 31, v1
    v_mul_u32_u24 v6, 272, v6
    v_lshrrev_b32_e64 v7, 5, v1
    v_lshl_add_u32 v6, v7, 5, v6
    s_lshl_b32 s50, s52, 6
    v_add_u32 v6, s50, v6
    v_lshrrev_b32 v8, 4, v1
    s_lshl_b32 s50, s52, 3
    v_add_u32 v8, s50, v8
    v_and_b32 v9, 15, v1
    v_lshlrev_b32_e64 v9, 4, v9
    v_mul_u32_u24 v7, 272, v8
    v_add_u32_e64 v7, v7, v9
    v_mul_u32_u24 v8, 2560, v8
    s_mul_i32 s50, s48, 163840
    s_lshl_b32 s51, s49, 8
    s_add_u32 s50, s50, s51
    s_add_u32 s50, s50, 1280
    v_add3_u32 v8, v8, v9, s50
    s_and_b32 s50, s49, 0
    s_mul_i32 s50, s50, 81920
    s_sub_u32 s51, 81920, s50
    v_add_u32 v10, s51, v8
    v_add_u32_e64 v8, s50, v8
    v_add_u32 v9, 10240, v8
    v_add_u32 v11, 10240, v10
    s_barrier
    s_nop 0
    ds_read_b128 v[16:19], v2 offset:0
    ds_read_b128 v[20:23], v2 offset:1024
    ds_read_b128 v[24:27], v2 offset:2048
    ds_read_b128 v[28:31], v2 offset:3072
    ds_read2st64_b32 v[32:33], v4 offset0:0 offset1:1
    ds_read2st64_b32 v[34:35], v4 offset0:2 offset1:3
    ds_read_b128 v[36:39], v2 offset:5120
    ds_read_b128 v[40:43], v2 offset:6144
    s_waitcnt lgkmcnt(6)
    s_nop 0
    v_mfma_f32_32x32x16_bf16 v[224:239], v[64:67], v[16:19], 0
    ds_read_b128 v[44:47], v2 offset:7168
    v_mfma_f32_32x32x16_bf16 v[224:239], v[68:71], v[20:23], v[224:239]
    ds_read_b128 v[16:19], v2 offset:8192
    s_waitcnt lgkmcnt(6)
    s_nop 0
    v_mfma_f32_32x32x16_bf16 v[224:239], v[72:75], v[24:27], v[224:239]
    ds_read2st64_b32 v[20:21], v4 offset0:20 offset1:21
    ds_read2st64_b32 v[22:23], v4 offset0:22 offset1:23
    v_mfma_f32_32x32x16_bf16 v[224:239], v[76:79], v[28:31], v[224:239]
    s_barrier
    ds_read_b128 v[24:27], v2 offset:10240
    s_waitcnt lgkmcnt(6)
    v_mfma_f32_32x32x16_bf16 v[224:239], v[80:83], v[32:35], v[224:239]
    ds_read_b128 v[28:31], v2 offset:11264
    v_mfma_f32_32x32x16_bf16 v[224:239], v[84:87], v[36:39], v[224:239]
    ds_read_b128 v[32:35], v2 offset:12288
    s_waitcnt lgkmcnt(6)
    s_nop 0
    v_mfma_f32_32x32x16_bf16 v[224:239], v[88:91], v[40:43], v[224:239]
    ds_read_b128 v[36:39], v2 offset:13312
    v_mfma_f32_32x32x16_bf16 v[224:239], v[92:95], v[44:47], v[224:239]
    ds_read2st64_b32 v[40:41], v4 offset0:40 offset1:41
    ds_read2st64_b32 v[42:43], v4 offset0:42 offset1:43
    s_waitcnt lgkmcnt(6)
    s_nop 0
    v_mfma_f32_32x32x16_bf16 v[224:239], v[96:99], v[16:19], v[224:239]
    ds_read_b128 v[44:47], v2 offset:15360
    v_mfma_f32_32x32x16_bf16 v[224:239], v[100:103], v[20:23], v[224:239]
    ds_read_b128 v[16:19], v2 offset:16384
    s_waitcnt lgkmcnt(6)
    s_nop 0
    v_mfma_f32_32x32x16_bf16 v[224:239], v[104:107], v[24:27], v[224:239]
    ds_read_b128 v[20:23], v2 offset:17408
    v_mfma_f32_32x32x16_bf16 v[224:239], v[108:111], v[28:31], v[224:239]
    ds_read_b128 v[24:27], v2 offset:18432
    s_waitcnt lgkmcnt(6)
    s_nop 0
    v_mfma_f32_32x32x16_bf16 v[224:239], v[112:115], v[32:35], v[224:239]
    ds_read2st64_b32 v[28:29], v4 offset0:60 offset1:61
    ds_read2st64_b32 v[30:31], v4 offset0:62 offset1:63
    v_mfma_f32_32x32x16_bf16 v[224:239], v[116:119], v[36:39], v[224:239]
    s_barrier
    ds_read_b128 v[32:35], v2 offset:20480
    s_waitcnt lgkmcnt(6)
    v_mfma_f32_32x32x16_bf16 v[224:239], v[120:123], v[40:43], v[224:239]
    ds_read_b128 v[36:39], v2 offset:21504
    v_mfma_f32_32x32x16_bf16 v[224:239], v[124:127], v[44:47], v[224:239]
    ds_read_b128 v[40:43], v2 offset:22528
    s_waitcnt lgkmcnt(6)
    s_nop 0
    v_mfma_f32_32x32x16_bf16 v[224:239], v[128:131], v[16:19], v[224:239]
    ds_read_b128 v[44:47], v2 offset:23552
    v_mfma_f32_32x32x16_bf16 v[224:239], v[132:135], v[20:23], v[224:239]
    ds_read2st64_b32 v[16:17], v4 offset0:80 offset1:81
    ds_read2st64_b32 v[18:19], v4 offset0:82 offset1:83
    s_waitcnt lgkmcnt(6)
    s_nop 0
    v_mfma_f32_32x32x16_bf16 v[224:239], v[136:139], v[24:27], v[224:239]
    ds_read_b128 v[20:23], v2 offset:25600
    v_mfma_f32_32x32x16_bf16 v[224:239], v[140:143], v[28:31], v[224:239]
    ds_read_b128 v[24:27], v2 offset:26624
    s_waitcnt lgkmcnt(6)
    s_nop 0
    v_mfma_f32_32x32x16_bf16 v[224:239], v[144:147], v[32:35], v[224:239]
    ds_read_b128 v[28:31], v2 offset:27648
    v_mfma_f32_32x32x16_bf16 v[224:239], v[148:151], v[36:39], v[224:239]
    ds_read_b128 v[32:35], v2 offset:28672
    s_waitcnt lgkmcnt(6)
    s_nop 0
    v_mfma_f32_32x32x16_bf16 v[224:239], v[152:155], v[40:43], v[224:239]
    ds_read2st64_b32 v[36:37], v4 offset0:100 offset1:101
    ds_read2st64_b32 v[38:39], v4 offset0:102 offset1:103
    v_mfma_f32_32x32x16_bf16 v[224:239], v[156:159], v[44:47], v[224:239]
    ds_read_b128 v[40:43], v2 offset:30720
    s_waitcnt lgkmcnt(6)
    s_nop 0
    v_mfma_f32_32x32x16_bf16 v[224:239], v[160:163], v[16:19], v[224:239]
    ds_read_b128 v[44:47], v2 offset:31744
    v_mfma_f32_32x32x16_bf16 v[224:239], v[164:167], v[20:23], v[224:239]
    ds_read_b128 v[16:19], v2 offset:32768
    s_waitcnt lgkmcnt(6)
    s_nop 0
    v_mfma_f32_32x32x16_bf16 v[224:239], v[168:171], v[24:27], v[224:239]
    ds_read_b128 v[20:23], v2 offset:33792
    v_mfma_f32_32x32x16_bf16 v[224:239], v[172:175], v[28:31], v[224:239]
    ds_read2st64_b32 v[24:25], v4 offset0:120 offset1:121
    ds_read2st64_b32 v[26:27], v4 offset0:122 offset1:123
    s_waitcnt lgkmcnt(6)
    s_nop 0
    v_mfma_f32_32x32x16_bf16 v[224:239], v[176:179], v[32:35], v[224:239]
    ds_read_b128 v[28:31], v2 offset:35840
    v_mfma_f32_32x32x16_bf16 v[224:239], v[180:183], v[36:39], v[224:239]
    ds_read_b128 v[32:35], v2 offset:36864
    s_waitcnt lgkmcnt(6)
    s_nop 0
    v_mfma_f32_32x32x16_bf16 v[224:239], v[184:187], v[40:43], v[224:239]
    ds_read_b128 v[36:39], v2 offset:37888
    v_mfma_f32_32x32x16_bf16 v[224:239], v[188:191], v[44:47], v[224:239]
    ds_read_b128 v[40:43], v2 offset:38912
    s_waitcnt lgkmcnt(6)
    s_nop 0
    v_mfma_f32_32x32x16_bf16 v[224:239], v[192:195], v[16:19], v[224:239]
    ds_read2st64_b32 v[44:45], v4 offset0:140 offset1:141
    ds_read2st64_b32 v[46:47], v4 offset0:142 offset1:143
    v_mfma_f32_32x32x16_bf16 v[224:239], v[196:199], v[20:23], v[224:239]
    s_barrier
    ds_read_b128 v[16:19], v3 offset:0
    s_waitcnt lgkmcnt(6)
    v_mfma_f32_32x32x16_bf16 v[224:239], v[200:203], v[24:27], v[224:239]
    ds_read_b128 v[20:23], v3 offset:1024
    v_mfma_f32_32x32x16_bf16 v[224:239], v[204:207], v[28:31], v[224:239]
    ds_read_b128 v[24:27], v3 offset:2048
    s_waitcnt lgkmcnt(6)
    s_nop 0
    v_mfma_f32_32x32x16_bf16 v[224:239], v[208:211], v[32:35], v[224:239]
    ds_read_b128 v[28:31], v3 offset:3072
    v_mfma_f32_32x32x16_bf16 v[224:239], v[212:215], v[36:39], v[224:239]
    ds_read2st64_b32 v[32:33], v5 offset0:0 offset1:1
    ds_read2st64_b32 v[34:35], v5 offset0:2 offset1:3
    s_waitcnt lgkmcnt(6)
    s_nop 0
    v_mfma_f32_32x32x16_bf16 v[224:239], v[216:219], v[40:43], v[224:239]
    ds_read_b128 v[36:39], v3 offset:5120
    v_mfma_f32_32x32x16_bf16 v[224:239], v[220:223], v[44:47], v[224:239]
    ds_read_b128 v[40:43], v3 offset:6144
    s_waitcnt lgkmcnt(6)
    s_nop 0
    v_mfma_f32_32x32x16_bf16 v[240:255], v[64:67], v[16:19], 0
    ds_read_b128 v[44:47], v3 offset:7168
    v_mfma_f32_32x32x16_bf16 v[240:255], v[68:71], v[20:23], v[240:255]
    ds_read_b128 v[16:19], v3 offset:8192
    s_waitcnt lgkmcnt(6)
    s_nop 0
    v_mfma_f32_32x32x16_bf16 v[240:255], v[72:75], v[24:27], v[240:255]
    ds_read2st64_b32 v[20:21], v5 offset0:20 offset1:21
    ds_read2st64_b32 v[22:23], v5 offset0:22 offset1:23
    v_mfma_f32_32x32x16_bf16 v[240:255], v[76:79], v[28:31], v[240:255]
    ds_read_b128 v[24:27], v3 offset:10240
    s_waitcnt lgkmcnt(6)
    s_nop 0
    v_mfma_f32_32x32x16_bf16 v[240:255], v[80:83], v[32:35], v[240:255]
    ds_read_b128 v[28:31], v3 offset:11264
    v_cvt_pk_bf16_f32 v48, v224, v225
    v_cvt_pk_bf16_f32 v49, v226, v227
    v_mfma_f32_32x32x16_bf16 v[240:255], v[84:87], v[36:39], v[240:255]
    ds_read_b128 v[32:35], v3 offset:12288
    v_cvt_pk_bf16_f32 v50, v228, v229
    v_cvt_pk_bf16_f32 v51, v230, v231
    s_waitcnt lgkmcnt(6)
    s_nop 0
    v_mfma_f32_32x32x16_bf16 v[240:255], v[88:91], v[40:43], v[240:255]
    ds_read_b128 v[36:39], v3 offset:13312
    v_cvt_pk_bf16_f32 v52, v232, v233
    v_cvt_pk_bf16_f32 v53, v234, v235
    v_mfma_f32_32x32x16_bf16 v[240:255], v[92:95], v[44:47], v[240:255]
    ds_read2st64_b32 v[40:41], v5 offset0:40 offset1:41
    ds_read2st64_b32 v[42:43], v5 offset0:42 offset1:43
    v_cvt_pk_bf16_f32 v54, v236, v237
    v_cvt_pk_bf16_f32 v55, v238, v239
    ds_write_b128 v6, v[48:51] offset:0
    s_waitcnt lgkmcnt(7)
    s_nop 0
    v_mfma_f32_32x32x16_bf16 v[240:255], v[96:99], v[16:19], v[240:255]
    ds_read_b128 v[44:47], v3 offset:15360
    v_mfma_f32_32x32x16_bf16 v[240:255], v[100:103], v[20:23], v[240:255]
    ds_read_b128 v[16:19], v3 offset:16384
    ds_write_b128 v6, v[52:55] offset:16
    s_waitcnt lgkmcnt(8)
    s_nop 0
    v_mfma_f32_32x32x16_bf16 v[240:255], v[104:107], v[24:27], v[240:255]
    ds_read_b128 v[20:23], v3 offset:17408
    v_mfma_f32_32x32x16_bf16 v[240:255], v[108:111], v[28:31], v[240:255]
    ds_read_b128 v[24:27], v3 offset:18432
    s_waitcnt lgkmcnt(8)
    s_nop 0
    v_mfma_f32_32x32x16_bf16 v[240:255], v[112:115], v[32:35], v[240:255]
    ds_read2st64_b32 v[28:29], v5 offset0:60 offset1:61
    ds_read2st64_b32 v[30:31], v5 offset0:62 offset1:63
    v_mfma_f32_32x32x16_bf16 v[240:255], v[116:119], v[36:39], v[240:255]
    s_waitcnt lgkmcnt(4)
    s_barrier
    ds_read_b128 v[32:35], v3 offset:20480
    v_mfma_f32_32x32x16_bf16 v[240:255], v[120:123], v[40:43], v[240:255]
    ds_read_b128 v[36:39], v3 offset:21504
    v_mfma_f32_32x32x16_bf16 v[240:255], v[124:127], v[44:47], v[240:255]
    ds_read_b128 v[40:43], v3 offset:22528
    s_waitcnt lgkmcnt(6)
    s_nop 0
    v_mfma_f32_32x32x16_bf16 v[240:255], v[128:131], v[16:19], v[240:255]
    ds_read_b128 v[44:47], v3 offset:23552
    ds_read_b128 v[48:51], v7 offset:0
    v_mfma_f32_32x32x16_bf16 v[240:255], v[132:135], v[20:23], v[240:255]
    ds_read2st64_b32 v[16:17], v5 offset0:80 offset1:81
    ds_read2st64_b32 v[18:19], v5 offset0:82 offset1:83
    s_waitcnt lgkmcnt(7)
    s_nop 0
    v_mfma_f32_32x32x16_bf16 v[240:255], v[136:139], v[24:27], v[240:255]
    ds_read_b128 v[20:23], v3 offset:25600
    ds_read_b128 v[52:55], v7 offset:1088
    v_mfma_f32_32x32x16_bf16 v[240:255], v[140:143], v[28:31], v[240:255]
    ds_read_b128 v[24:27], v3 offset:26624
    s_waitcnt lgkmcnt(8)
    s_nop 0
    v_mfma_f32_32x32x16_bf16 v[240:255], v[144:147], v[32:35], v[240:255]
    ds_read_b128 v[28:31], v3 offset:27648
    v_mfma_f32_32x32x16_bf16 v[240:255], v[148:151], v[36:39], v[240:255]
    ds_read_b128 v[32:35], v3 offset:28672
    s_waitcnt lgkmcnt(8)
    s_nop 0
    v_mfma_f32_32x32x16_bf16 v[240:255], v[152:155], v[40:43], v[240:255]
    ds_read2st64_b32 v[36:37], v5 offset0:100 offset1:101
    ds_read2st64_b32 v[38:39], v5 offset0:102 offset1:103
    s_waitcnt lgkmcnt(9)
    s_nop 0
    global_store_dwordx4 v8, v[48:51], s[18:19] sc1
    v_mfma_f32_32x32x16_bf16 v[240:255], v[156:159], v[44:47], v[240:255]
    ds_read_b128 v[40:43], v3 offset:30720
    s_waitcnt lgkmcnt(7)
    v_mfma_f32_32x32x16_bf16 v[240:255], v[160:163], v[16:19], v[240:255]
    ds_read_b128 v[44:47], v3 offset:31744
    s_waitcnt lgkmcnt(7)
    global_store_dwordx4 v9, v[52:55], s[18:19] sc1
    v_mfma_f32_32x32x16_bf16 v[240:255], v[164:167], v[20:23], v[240:255]
    ds_read_b128 v[16:19], v3 offset:32768
    s_waitcnt lgkmcnt(6)
    s_nop 0
    v_mfma_f32_32x32x16_bf16 v[240:255], v[168:171], v[24:27], v[240:255]
    ds_read_b128 v[20:23], v3 offset:33792
    v_mfma_f32_32x32x16_bf16 v[240:255], v[172:175], v[28:31], v[240:255]
    ds_read2st64_b32 v[24:25], v5 offset0:120 offset1:121
    ds_read2st64_b32 v[26:27], v5 offset0:122 offset1:123
    s_waitcnt lgkmcnt(6)
    s_nop 0
    v_mfma_f32_32x32x16_bf16 v[240:255], v[176:179], v[32:35], v[240:255]
    ds_read_b128 v[28:31], v3 offset:35840
    v_mfma_f32_32x32x16_bf16 v[240:255], v[180:183], v[36:39], v[240:255]
    ds_read_b128 v[32:35], v3 offset:36864
    s_waitcnt lgkmcnt(6)
    s_nop 0
    v_mfma_f32_32x32x16_bf16 v[240:255], v[184:187], v[40:43], v[240:255]
    ds_read_b128 v[36:39], v3 offset:37888
    v_mfma_f32_32x32x16_bf16 v[240:255], v[188:191], v[44:47], v[240:255]
    ds_read_b128 v[40:43], v3 offset:38912
    s_waitcnt lgkmcnt(6)
    s_nop 0
    v_mfma_f32_32x32x16_bf16 v[240:255], v[192:195], v[16:19], v[240:255]
    ds_read2st64_b32 v[44:45], v5 offset0:140 offset1:141
    ds_read2st64_b32 v[46:47], v5 offset0:142 offset1:143
    v_mfma_f32_32x32x16_bf16 v[240:255], v[196:199], v[20:23], v[240:255]
    s_waitcnt lgkmcnt(5)
    v_mfma_f32_32x32x16_bf16 v[240:255], v[200:203], v[24:27], v[240:255]
    v_mfma_f32_32x32x16_bf16 v[240:255], v[204:207], v[28:31], v[240:255]
    s_waitcnt lgkmcnt(3)
    v_mfma_f32_32x32x16_bf16 v[240:255], v[208:211], v[32:35], v[240:255]
    v_mfma_f32_32x32x16_bf16 v[240:255], v[212:215], v[36:39], v[240:255]
    s_waitcnt lgkmcnt(0)
    v_mfma_f32_32x32x16_bf16 v[240:255], v[216:219], v[40:43], v[240:255]
    v_mfma_f32_32x32x16_bf16 v[240:255], v[220:223], v[44:47], v[240:255]
    s_nop 11
    v_cvt_pk_bf16_f32 v48, v240, v241
    v_cvt_pk_bf16_f32 v49, v242, v243
    v_cvt_pk_bf16_f32 v50, v244, v245
    v_cvt_pk_bf16_f32 v51, v246, v247
    ds_write_b128 v6, v[48:51] offset:8704
    v_cvt_pk_bf16_f32 v52, v248, v249
    v_cvt_pk_bf16_f32 v53, v250, v251
    v_cvt_pk_bf16_f32 v54, v252, v253
    v_cvt_pk_bf16_f32 v55, v254, v255
    ds_write_b128 v6, v[52:55] offset:8720
    s_waitcnt lgkmcnt(0)
    s_barrier
    ds_read_b128 v[48:51], v7 offset:8704
    ds_read_b128 v[52:55], v7 offset:9792
    s_waitcnt lgkmcnt(1)
    global_store_dwordx4 v10, v[48:51], s[18:19]
    s_waitcnt lgkmcnt(0)
    global_store_dwordx4 v11, v[52:55], s[18:19]
B_EXIT:
    s_endpgm
B_WDIR0:
    s_mov_b32 s51, s55
    s_mov_b32 s62, 0
    s_cmp_ge_u32 s59, 10
    s_cselect_b32 s50, 10, 0
    s_sub_u32 s50, s59, s50
    s_mul_i32 s50, s50, 245760
    s_mul_i32 s54, s3, 80
    s_add_u32 s54, s54, s50
    s_add_u32 s59, s59, 1
B_WDIR_L0:
    s_mov_b32 m0, s51
    s_nop 0
    s_add_u32 s51, s51, 1920
    buffer_load_dwordx4 v10, s[28:31], s54 offen lds
    s_mov_b32 exec_hi, 0x00ffffff
    buffer_load_dwordx4 v11, s[28:31], s54 offen offset:1024 lds
    s_mov_b64 exec, -1
    s_add_u32 s54, s54, 30720
    s_add_u32 s62, s62, 1
    s_cmp_lt_u32 s62, 8
    s_cbranch_scc1 B_WDIR_L0
    s_branch B_WDONE0
B_WDIR:
    s_waitcnt vmcnt(0)
    s_barrier
    s_mov_b32 s51, s55
    s_mov_b32 s62, 0
    s_cmp_ge_u32 s59, 10
    s_cselect_b32 s50, 10, 0
    s_sub_u32 s50, s59, s50
    s_mul_i32 s50, s50, 245760
    s_mul_i32 s54, s3, 80
    s_add_u32 s54, s54, s50
    s_add_u32 s59, s59, 1
B_WDIR_L:
    s_mov_b32 m0, s51
    s_nop 0
    s_add_u32 s51, s51, 1920
    buffer_load_dwordx4 v10, s[28:31], s54 offen lds
    s_mov_b32 exec_hi, 0x00ffffff
    buffer_load_dwordx4 v11, s[28:31], s54 offen offset:1024 lds
    s_mov_b64 exec, -1
    s_add_u32 s54, s54, 30720
    s_add_u32 s62, s62, 1
    s_cmp_lt_u32 s62, 8
    s_cbranch_scc1 B_WDIR_L
    s_branch B_WDONE
    s_endpgm
L_ROLE_A:
    s_sub_u32 s58, s6, 22
    s_lshl_b32 s58, s58, 3
    s_add_u32 s58, s58, s4
    s_and_b32 s59, s58, 1
    s_lshr_b32 s58, s58, 1
    s_mul_i32 s58, s58, 3840
    s_lshl_b32 s57, s5, 1
    s_add_u32 s59, s59, s57
    s_mul_i32 s59, s59, 153600
    s_add_u32 s58, s58, s59
PG_A0:
    s_cbranch_execz PG_A1
    s_nop 0
    s_add_u32 s58, s58, 1572864
    v_lshl_add_u32 v4, v1, 7, s58
    s_lshl_b32 s45, s7, 3
    s_add_u32 s45, s45, s4
    s_lshl_b32 s45, s45, 12
    v_and_b32 v5, 31, v1
    v_lshl_add_u32 v5, v5, 7, s45
    s_mov_b64 exec, 0x3fffffff
    global_load_dword v250, v4, s[62:63]
    s_mov_b64 exec, -1
    s_barrier
    s_mov_b64 exec, 0xffffffff
    global_load_dword v250, v5, s[64:65]
    s_mov_b64 exec, -1
    s_lshl_b32 s28, s28, 1
    s_mul_i32 s32, s4, 8704
    s_mul_i32 s33, s4, 4608
    s_add_u32 s33, s33, 69632
    s_lshl_b32 s56, s4, 12
    s_add_u32 s56, s56, 106496
    s_mov_b32 m0, s32
    s_mov_b32 s34, 0x3fb8aa3b
    s_mov_b32 s35, 0x32a57060
    s_mov_b32 s39, 0x3f317218
    s_mov_b32 s38, 0x41000000
    s_mov_b32 s40, 0x43800000
    s_mov_b32 s42, 0x05040100
    s_mov_b32 s43, 0x07060302
    s_mov_b32 s50, 0
    s_mov_b32 s51, -1
    s_mov_b32 s60, 0x55555555
    s_mov_b32 s61, 0x55555555
    s_mov_b32 s52, s8
    s_mov_b32 s53, s9
    s_mov_b32 s54, 2621440
    s_mov_b32 s55, 0x20000
    v_and_b32_e64 v5, 31, v1
    v_mul_u32_u24 v5, 272, v5
    v_lshrrev_b32_e64 v6, 5, v1
    v_lshl_add_u32 v5, v6, 4, v5
    v_add_u32_e64 v79, s32, v5
    v_mov_b32 v78, 0x3f80
    s_lshr_b32 s58, s28, 4
    v_add_u32 v7, s58, v1
    v_and_b32_e64 v7, 3, v7
    v_lshl_add_u32 v6, v0, 2, v7
    v_xor_b32_e64 v241, 0, v6
    v_mul_u32_u24 v241, 1280, v241
    v_xor_b32_e64 v242, 1, v6
    v_mul_u32_u24 v242, 1280, v242
    v_xor_b32_e64 v243, 2, v6
    v_mul_u32_u24 v243, 1280, v243
    v_xor_b32_e64 v244, 3, v6
    v_mul_u32_u24 v244, 1280, v244
    s_bfe_u32 s45, s28, 0x10006
    s_mul_i32 s66, s45, 1310720
    s_sub_u32 s67, 1310720, s66
    s_add_u32 s66, s66, s28
    s_add_u32 s67, s67, s28
    s_lshl_b32 s45, s45, 14
    s_add_u32 s68, s56, s45
    s_sub_u32 s69, s56, s45
    s_add_u32 s69, s69, 16384
    s_waitcnt lgkmcnt(0)
    s_and_b32 s31, s29, 1
    s_lshl_b32 s31, s31, 4
    s_lshr_b32 s48, s48, s31
    s_lshl_b32 s48, s48, 16
    s_lshr_b32 s49, s49, s31
    s_lshl_b32 s49, s49, 16
    v_mov_b32 v44, s48
    v_mov_b32 v45, 0
    v_writelane_b32 v45, s49, 0
    v_mul_f32_e64 v5, s34, v44
    v_fma_f32 v6, v44, s34, -v5
    v_fma_f32 v6, v44, s35, v6
    v_exp_f32 v5, v5
    v_mul_f32 v6, s39, v6
    v_fma_f32 v5, v5, v6, v5
    v_cvt_pk_bf16_f32 v5, v5, v5
    v_and_b32 v44, 0xffff0000, v5
    v_mul_f32 v46, s34, v44
    v_mul_f32 v47, 0.15915494, v44
    s_cmp_lg_u32 s4, 7
    s_cbranch_scc1 A_NOWARM
    s_mov_b64 exec, 0
    s_branch PG_A0
PG_A_RET:
    s_mov_b64 exec, -1
A_NOWARM:
    s_waitcnt vmcnt(8)
    s_cmp_ge_u32 s6, 30
    s_cselect_b32 s45, 1, 0
    s_cmp_ge_u32 s4, 4
    s_cselect_b32 s45, 2, s45
    v_lshlrev_b32 v20, 16, v8
    v_lshlrev_b32 v21, 16, v9
    v_lshlrev_b32 v22, 16, v10
    v_lshlrev_b32 v23, 16, v11
    v_lshlrev_b32 v24, 16, v12
    v_lshlrev_b32 v25, 16, v13
    v_mul_f32 v48, v20, v46
    v_mul_f32 v49, v21, v47
    v_mul_f32 v64, s38, v48
    v_mul_f32 v65, s38, v49
    v_mul_f32 v66, s40, v48
    v_mul_f32 v67, s40, v49
    v_exp_f32 v186, v64
    v_fract_f32 v187, v65
    v_exp_f32 v190, v66
    v_cos_f32 v56, v187
    v_sin_f32 v57, v187
    v_mul_f32 v56, v56, v186
    v_mul_f32 v57, v57, v186
    v_mul_f32 v188, v56, v56
    v_mul_f32_e64 v189, v56, v57
    v_fma_f32 v58, -v57, v57, v188
    v_fma_f32 v59, v57, v56, v189
    v_fract_f32 v191, v67
    v_exp_f32 v192, v48
    v_cos_f32 v60, v191
    v_sin_f32 v61, v191
    v_mul_f32 v60, v60, v190
    v_mul_f32 v61, v61, v190
    v_fract_f32 v193, v49
    v_mul_f32 v194, v22, v24
    v_cos_f32 v50, v193
    v_sin_f32 v51, v193
    v_mul_f32 v50, v50, v192
    v_mul_f32 v51, v51, v192
    v_mul_f32_e64 v195, v22, v25
    v_fma_f32 v62, -v23, v25, v194
    v_fma_f32 v63, v23, v24, v195
    v_mul_f32 v62, v62, v44
    v_mul_f32 v63, v63, v44
    ds_write_addtid_b32 v78 offset:0
    v_cvt_pk_bf16_f32 v197, v56, v57
    v_cvt_pk_bf16_f32 v198, v58, v59
    v_pk_mul_f32 v[184:185], v[56:57], v[58:59] op_sel:[0,0] op_sel_hi:[0,1]
    ds_write_addtid_b32 v197 offset:272
    v_pk_mul_f32 v[186:187], v[58:59], v[58:59] op_sel:[0,0] op_sel_hi:[0,1]
    v_pk_fma_f32 v[162:163], v[56:57], v[58:59], v[184:185] op_sel:[1,1,0] op_sel_hi:[1,0,1] neg_lo:[0,1,0]
    ds_write_addtid_b32 v198 offset:544
    v_pk_fma_f32 v[164:165], v[58:59], v[58:59], v[186:187] op_sel:[1,1,0] op_sel_hi:[1,0,1] neg_lo:[0,1,0]
    v_cvt_pk_bf16_f32 v199, v162, v163
    v_pk_mul_f32 v[188:189], v[162:163], v[58:59] op_sel:[0,0] op_sel_hi:[0,1]
    v_cvt_pk_bf16_f32 v200, v164, v165
    ds_write_addtid_b32 v199 offset:816
    v_pk_fma_f32 v[166:167], v[162:163], v[58:59], v[188:189] op_sel:[1,1,0] op_sel_hi:[1,0,1] neg_lo:[0,1,0]
    v_pk_mul_f32 v[190:191], v[164:165], v[58:59] op_sel:[0,0] op_sel_hi:[0,1]
    ds_write_addtid_b32 v200 offset:1088
    v_cvt_pk_bf16_f32 v201, v166, v167
    v_pk_fma_f32 v[168:169], v[164:165], v[58:59], v[190:191] op_sel:[1,1,0] op_sel_hi:[1,0,1] neg_lo:[0,1,0]
    v_pk_mul_f32 v[192:193], v[166:167], v[58:59] op_sel:[0,0] op_sel_hi:[0,1]
    ds_write_addtid_b32 v201 offset:1360
    v_cvt_pk_bf16_f32 v202, v168, v169
    v_pk_fma_f32 v[170:171], v[166:167], v[58:59], v[192:193] op_sel:[1,1,0] op_sel_hi:[1,0,1] neg_lo:[0,1,0]
    v_pk_mul_f32 v[194:195], v[168:169], v[58:59] op_sel:[0,0] op_sel_hi:[0,1]
    ds_write_addtid_b32 v202 offset:1632
    v_cvt_pk_bf16_f32 v203, v170, v171
    v_pk_fma_f32 v[172:173], v[168:169], v[58:59], v[194:195] op_sel:[1,1,0] op_sel_hi:[1,0,1] neg_lo:[0,1,0]
    v_pk_mul_f32 v[184:185], v[170:171], v[58:59] op_sel:[0,0] op_sel_hi:[0,1]
    ds_write_addtid_b32 v203 offset:1904
    v_cvt_pk_bf16_f32 v196, v172, v173
    v_pk_fma_f32 v[174:175], v[170:171], v[58:59], v[184:185] op_sel:[1,1,0] op_sel_hi:[1,0,1] neg_lo:[0,1,0]
    v_pk_mul_f32 v[186:187], v[172:173], v[58:59] op_sel:[0,0] op_sel_hi:[0,1]
    ds_write_addtid_b32 v196 offset:2176
    v_cvt_pk_bf16_f32 v197, v174, v175
    v_pk_fma_f32 v[176:177], v[172:173], v[58:59], v[186:187] op_sel:[1,1,0] op_sel_hi:[1,0,1] neg_lo:[0,1,0]
    v_pk_mul_f32 v[188:189], v[174:175], v[58:59] op_sel:[0,0] op_sel_hi:[0,1]
    ds_write_addtid_b32 v197 offset:2448
    v_cvt_pk_bf16_f32 v198, v176, v177
    v_pk_fma_f32 v[178:179], v[174:175], v[58:59], v[188:189] op_sel:[1,1,0] op_sel_hi:[1,0,1] neg_lo:[0,1,0]
    v_pk_mul_f32 v[190:191], v[176:177], v[58:59] op_sel:[0,0] op_sel_hi:[0,1]
    ds_write_addtid_b32 v198 offset:2720
    v_cvt_pk_bf16_f32 v199, v178, v179
    v_pk_fma_f32 v[180:181], v[176:177], v[58:59], v[190:191] op_sel:[1,1,0] op_sel_hi:[1,0,1] neg_lo:[0,1,0]
    v_pk_mul_f32 v[192:193], v[178:179], v[58:59] op_sel:[0,0] op_sel_hi:[0,1]
    ds_write_addtid_b32 v199 offset:2992
    v_cvt_pk_bf16_f32 v200, v180, v181
    v_pk_fma_f32 v[182:183], v[178:179], v[58:59], v[192:193] op_sel:[1,1,0] op_sel_hi:[1,0,1] neg_lo:[0,1,0]
    v_pk_mul_f32 v[194:195], v[180:181], v[58:59] op_sel:[0,0] op_sel_hi:[0,1]
    ds_write_addtid_b32 v200 offset:3264
    v_cvt_pk_bf16_f32 v201, v182, v183
    v_pk_fma_f32 v[160:161], v[180:181], v[58:59], v[194:195] op_sel:[1,1,0] op_sel_hi:[1,0,1] neg_lo:[0,1,0]
    v_pk_mul_f32 v[184:185], v[182:183], v[58:59] op_sel:[0,0] op_sel_hi:[0,1]
    ds_write_addtid_b32 v201 offset:3536
    v_cvt_pk_bf16_f32 v202, v160, v161
    v_pk_fma_f32 v[162:163], v[182:183], v[58:59], v[184:185] op_sel:[1,1,0] op_sel_hi:[1,0,1] neg_lo:[0,1,0]
    v_pk_mul_f32 v[186:187], v[160:161], v[58:59] op_sel:[0,0] op_sel_hi:[0,1]
    ds_write_addtid_b32 v202 offset:3808
    v_cvt_pk_bf16_f32 v203, v162, v163
    v_pk_fma_f32 v[164:165], v[160:161], v[58:59], v[186:187] op_sel:[1,1,0] op_sel_hi:[1,0,1] neg_lo:[0,1,0]
    v_pk_mul_f32 v[188:189], v[162:163], v[58:59] op_sel:[0,0] op_sel_hi:[0,1]
    ds_write_addtid_b32 v203 offset:4080
    v_cvt_pk_bf16_f32 v196, v164, v165
    v_pk_fma_f32 v[166:167], v[162:163], v[58:59], v[188:189] op_sel:[1,1,0] op_sel_hi:[1,0,1] neg_lo:[0,1,0]
    v_pk_mul_f32 v[190:191], v[164:165], v[58:59] op_sel:[0,0] op_sel_hi:[0,1]
    ds_write_addtid_b32 v196 offset:4352
    v_cvt_pk_bf16_f32 v197, v166, v167
    v_pk_fma_f32 v[168:169], v[164:165], v[58:59], v[190:191] op_sel:[1,1,0] op_sel_hi:[1,0,1] neg_lo:[0,1,0]
    v_pk_mul_f32 v[192:193], v[166:167], v[58:59] op_sel:[0,0] op_sel_hi:[0,1]
    ds_write_addtid_b32 v197 offset:4624
    v_cvt_pk_bf16_f32 v198, v168, v169
    v_pk_fma_f32 v[170:171], v[166:167], v[58:59], v[192:193] op_sel:[1,1,0] op_sel_hi:[1,0,1] neg_lo:[0,1,0]
    v_pk_mul_f32 v[194:195], v[168:169], v[58:59] op_sel:[0,0] op_sel_hi:[0,1]
    ds_write_addtid_b32 v198 offset:4896
    v_cvt_pk_bf16_f32 v199, v170, v171
    v_pk_fma_f32 v[172:173], v[168:169], v[58:59], v[194:195] op_sel:[1,1,0] op_sel_hi:[1,0,1] neg_lo:[0,1,0]
    v_pk_mul_f32 v[184:185], v[170:171], v[58:59] op_sel:[0,0] op_sel_hi:[0,1]
    ds_write_addtid_b32 v199 offset:5168
    v_cvt_pk_bf16_f32 v200, v172, v173
    v_pk_fma_f32 v[174:175], v[170:171], v[58:59], v[184:185] op_sel:[1,1,0] op_sel_hi:[1,0,1] neg_lo:[0,1,0]
    v_pk_mul_f32 v[186:187], v[172:173], v[58:59] op_sel:[0,0] op_sel_hi:[0,1]
    ds_write_addtid_b32 v200 offset:5440
    v_cvt_pk_bf16_f32 v201, v174, v175
    v_pk_fma_f32 v[176:177], v[172:173], v[58:59], v[186:187] op_sel:[1,1,0] op_sel_hi:[1,0,1] neg_lo:[0,1,0]
    v_pk_mul_f32 v[188:189], v[174:175], v[58:59] op_sel:[0,0] op_sel_hi:[0,1]
    ds_write_addtid_b32 v201 offset:5712
    v_cvt_pk_bf16_f32 v202, v176, v177
    v_pk_fma_f32 v[178:179], v[174:175], v[58:59], v[188:189] op_sel:[1,1,0] op_sel_hi:[1,0,1] neg_lo:[0,1,0]
    v_pk_mul_f32 v[190:191], v[176:177], v[58:59] op_sel:[0,0] op_sel_hi:[0,1]
    ds_write_addtid_b32 v202 offset:5984
    v_cvt_pk_bf16_f32 v203, v178, v179
    v_pk_fma_f32 v[180:181], v[176:177], v[58:59], v[190:191] op_sel:[1,1,0] op_sel_hi:[1,0,1] neg_lo:[0,1,0]
    v_pk_mul_f32 v[192:193], v[178:179], v[58:59] op_sel:[0,0] op_sel_hi:[0,1]
    ds_write_addtid_b32 v203 offset:6256
    v_cvt_pk_bf16_f32 v196, v180, v181
    v_pk_fma_f32 v[182:183], v[178:179], v[58:59], v[192:193] op_sel:[1,1,0] op_sel_hi:[1,0,1] neg_lo:[0,1,0]
    v_pk_mul_f32 v[194:195], v[180:181], v[58:59] op_sel:[0,0] op_sel_hi:[0,1]
    ds_write_addtid_b32 v196 offset:6528
    v_cvt_pk_bf16_f32 v197, v182, v183
    v_pk_fma_f32 v[160:161], v[180:181], v[58:59], v[194:195] op_sel:[1,1,0] op_sel_hi:[1,0,1] neg_lo:[0,1,0]
    v_pk_mul_f32 v[184:185], v[182:183], v[58:59] op_sel:[0,0] op_sel_hi:[0,1]
    ds_write_addtid_b32 v197 offset:6800
    v_cvt_pk_bf16_f32 v198, v160, v161
    v_pk_fma_f32 v[162:163], v[182:183], v[58:59], v[184:185] op_sel:[1,1,0] op_sel_hi:[1,0,1] neg_lo:[0,1,0]
    v_pk_mul_f32 v[186:187], v[160:161], v[58:59] op_sel:[0,0] op_sel_hi:[0,1]
    ds_write_addtid_b32 v198 offset:7072
    v_cvt_pk_bf16_f32 v199, v162, v163
    v_pk_fma_f32 v[164:165], v[160:161], v[58:59], v[186:187] op_sel:[1,1,0] op_sel_hi:[1,0,1] neg_lo:[0,1,0]
    v_pk_mul_f32 v[188:189], v[162:163], v[58:59] op_sel:[0,0] op_sel_hi:[0,1]
    ds_write_addtid_b32 v199 offset:7344
    v_cvt_pk_bf16_f32 v200, v164, v165
    v_pk_fma_f32 v[166:167], v[162:163], v[58:59], v[188:189] op_sel:[1,1,0] op_sel_hi:[1,0,1] neg_lo:[0,1,0]
    v_pk_mul_f32 v[190:191], v[164:165], v[58:59] op_sel:[0,0] op_sel_hi:[0,1]
    ds_write_addtid_b32 v200 offset:7616
    v_cvt_pk_bf16_f32 v201, v166, v167
    v_pk_fma_f32 v[168:169], v[164:165], v[58:59], v[190:191] op_sel:[1,1,0] op_sel_hi:[1,0,1] neg_lo:[0,1,0]
    v_pk_mul_f32 v[192:193], v[166:167], v[58:59] op_sel:[0,0] op_sel_hi:[0,1]
    ds_write_addtid_b32 v201 offset:7888
    v_cvt_pk_bf16_f32 v202, v168, v169
    v_pk_fma_f32 v[170:171], v[166:167], v[58:59], v[192:193] op_sel:[1,1,0] op_sel_hi:[1,0,1] neg_lo:[0,1,0]
    v_pk_mul_f32 v[194:195], v[50:51], v[50:51] op_sel:[0,0] op_sel_hi:[0,1]
    ds_write_addtid_b32 v202 offset:8160
    v_cvt_pk_bf16_f32 v203, v170, v171
    v_pk_fma_f32 v[52:53], v[50:51], v[50:51], v[194:195] op_sel:[1,1,0] op_sel_hi:[1,0,1] neg_lo:[0,1,0]
    v_pk_mul_f32 v[186:187], v[62:63], v[60:61] op_sel:[0,0] op_sel_hi:[0,1]
    ds_write_addtid_b32 v203 offset:8432
    v_pk_mul_f32 v[184:185], v[52:53], v[52:53] op_sel:[0,0] op_sel_hi:[0,1]
    v_pk_fma_f32 v[204:205], v[62:63], v[60:61], v[186:187] op_sel:[1,1,0] op_sel_hi:[1,0,1] neg_lo:[0,1,0]
    v_cvt_pk_bf16_f32 v196, v62, -v63
    ds_read_b128 v[80:83], v79 offset:0
    v_pk_fma_f32 v[54:55], v[52:53], v[52:53], v[184:185] op_sel:[1,1,0] op_sel_hi:[1,0,1] neg_lo:[0,1,0]
    v_pk_mul_f32 v[188:189], v[204:205], v[60:61] op_sel:[0,0] op_sel_hi:[0,1]
    v_cvt_pk_bf16_f32 v198, v204, -v205
    ds_read_b128 v[84:87], v79 offset:32
    v_pk_fma_f32 v[206:207], v[204:205], v[60:61], v[188:189] op_sel:[1,1,0] op_sel_hi:[1,0,1] neg_lo:[0,1,0]
    ds_read_b128 v[88:91], v79 offset:64
    ds_read_b128 v[92:95], v79 offset:96
    v_pk_mul_f32 v[190:191], v[206:207], v[60:61] op_sel:[0,0] op_sel_hi:[0,1]
    v_cvt_pk_bf16_f32 v201, v206, -v207
    ds_read_b128 v[96:99], v79 offset:128
    v_pk_fma_f32 v[208:209], v[206:207], v[60:61], v[190:191] op_sel:[1,1,0] op_sel_hi:[1,0,1] neg_lo:[0,1,0]
    v_pk_mul_f32 v[190:191], v[62:63], v[50:51] op_sel:[0,0] op_sel_hi:[0,1]
    ds_read_b128 v[100:103], v79 offset:160
    v_pk_mul_f32 v[192:193], v[208:209], v[60:61] op_sel:[0,0] op_sel_hi:[0,1]
    v_pk_fma_f32 v[172:173], v[62:63], v[50:51], v[190:191] op_sel:[1,1,0] op_sel_hi:[1,0,1] neg_lo:[0,1,0]
    ds_read_b128 v[104:107], v79 offset:192
    v_pk_fma_f32 v[210:211], v[208:209], v[60:61], v[192:193] op_sel:[1,1,0] op_sel_hi:[1,0,1] neg_lo:[0,1,0]
    v_cvt_pk_bf16_f32 v197, v172, -v173
    v_pk_mul_f32 v[192:193], v[204:205], v[52:53] op_sel:[0,0] op_sel_hi:[0,1]
    ds_read_b128 v[108:111], v79 offset:224
    v_pk_mul_f32 v[194:195], v[210:211], v[60:61] op_sel:[0,0] op_sel_hi:[0,1]
    v_pk_fma_f32 v[174:175], v[204:205], v[52:53], v[192:193] op_sel:[1,1,0] op_sel_hi:[1,0,1] neg_lo:[0,1,0]
    v_pk_mul_f32 v[192:193], v[206:207], v[54:55] op_sel:[0,0] op_sel_hi:[0,1]
    ds_write_addtid_b32 v196 offset:0
    v_pk_fma_f32 v[212:213], v[210:211], v[60:61], v[194:195] op_sel:[1,1,0] op_sel_hi:[1,0,1] neg_lo:[0,1,0]
    v_cvt_pk_bf16_f32 v199, v174, -v175
    v_pk_mul_f32 v[194:195], v[172:173], v[50:51] op_sel:[0,0] op_sel_hi:[0,1]
    ds_write_addtid_b32 v197 offset:272
    v_pk_mul_f32 v[184:185], v[212:213], v[60:61] op_sel:[0,0] op_sel_hi:[0,1]
    v_pk_fma_f32 v[176:177], v[172:173], v[50:51], v[194:195] op_sel:[1,1,0] op_sel_hi:[1,0,1] neg_lo:[0,1,0]
    v_cvt_pk_bf16_f32 v196, v208, -v209
    ds_write_addtid_b32 v198 offset:1088
    v_pk_fma_f32 v[214:215], v[212:213], v[60:61], v[184:185] op_sel:[1,1,0] op_sel_hi:[1,0,1] neg_lo:[0,1,0]
    v_cvt_pk_bf16_f32 v200, v176, -v177
    v_pk_mul_f32 v[184:185], v[174:175], v[52:53] op_sel:[0,0] op_sel_hi:[0,1]
    ds_write_addtid_b32 v198 offset:1360
    v_pk_mul_f32 v[186:187], v[214:215], v[60:61] op_sel:[0,0] op_sel_hi:[0,1]
    v_pk_fma_f32 v[178:179], v[174:175], v[52:53], v[184:185] op_sel:[1,1,0] op_sel_hi:[1,0,1] neg_lo:[0,1,0]
    v_pk_fma_f32 v[162:163], v[206:207], v[54:55], v[192:193] op_sel:[1,1,0] op_sel_hi:[1,0,1] neg_lo:[0,1,0]
    ds_write_addtid_b32 v199 offset:1632
    v_pk_fma_f32 v[216:217], v[214:215], v[60:61], v[186:187] op_sel:[1,1,0] op_sel_hi:[1,0,1] neg_lo:[0,1,0]
    v_cvt_pk_bf16_f32 v202, v178, -v179
    v_pk_mul_f32 v[186:187], v[176:177], v[50:51] op_sel:[0,0] op_sel_hi:[0,1]
    ds_write_addtid_b32 v200 offset:544
    v_pk_mul_f32 v[188:189], v[216:217], v[60:61] op_sel:[0,0] op_sel_hi:[0,1]
    v_pk_fma_f32 v[180:181], v[176:177], v[50:51], v[186:187] op_sel:[1,1,0] op_sel_hi:[1,0,1] neg_lo:[0,1,0]
    v_cvt_pk_bf16_f32 v199, v210, -v211
    ds_write_addtid_b32 v201 offset:4352
    v_pk_fma_f32 v[218:219], v[216:217], v[60:61], v[188:189] op_sel:[1,1,0] op_sel_hi:[1,0,1] neg_lo:[0,1,0]
    v_cvt_pk_bf16_f32 v203, v180, -v181
    v_pk_mul_f32 v[188:189], v[178:179], v[52:53] op_sel:[0,0] op_sel_hi:[0,1]
    ds_write_addtid_b32 v202 offset:1904
    v_pk_mul_f32 v[190:191], v[180:181], v[50:51] op_sel:[0,0] op_sel_hi:[0,1]
    v_pk_fma_f32 v[182:183], v[178:179], v[52:53], v[188:189] op_sel:[1,1,0] op_sel_hi:[1,0,1] neg_lo:[0,1,0]
    v_cvt_pk_bf16_f32 v200, v162, -v163
    ds_write_addtid_b32 v202 offset:3264
    v_cvt_pk_bf16_f32 v197, v182, -v183
    v_pk_fma_f32 v[160:161], v[180:181], v[50:51], v[190:191] op_sel:[1,1,0] op_sel_hi:[1,0,1] neg_lo:[0,1,0]
    v_pk_mul_f32 v[184:185], v[208:209], v[54:55] op_sel:[0,0] op_sel_hi:[0,1]
    ds_write_addtid_b32 v202 offset:3536
    v_cvt_pk_bf16_f32 v198, v160, -v161
    v_pk_mul_f32 v[194:195], v[160:161], v[50:51] op_sel:[0,0] op_sel_hi:[0,1]
    v_cvt_pk_bf16_f32 v202, v212, -v213
    ds_write_addtid_b32 v203 offset:816
    v_pk_fma_f32 v[164:165], v[160:161], v[50:51], v[194:195] op_sel:[1,1,0] op_sel_hi:[1,0,1] neg_lo:[0,1,0]
    v_pk_fma_f32 v[166:167], v[208:209], v[54:55], v[184:185] op_sel:[1,1,0] op_sel_hi:[1,0,1] neg_lo:[0,1,0]
    ds_write_addtid_b32 v196 offset:5440
    v_cvt_pk_bf16_f32 v201, v164, -v165
    v_cvt_pk_bf16_f32 v203, v166, -v167
    v_pk_mul_f32 v[186:187], v[164:165], v[50:51] op_sel:[0,0] op_sel_hi:[0,1]
    ds_write_addtid_b32 v197 offset:3808
    v_cvt_pk_bf16_f32 v197, v214, -v215
    v_pk_fma_f32 v[168:169], v[164:165], v[50:51], v[186:187] op_sel:[1,1,0] op_sel_hi:[1,0,1] neg_lo:[0,1,0]
    ds_write_addtid_b32 v198 offset:2176
    v_cvt_pk_bf16_f32 v198, v216, -v217
    v_cvt_pk_bf16_f32 v196, v168, -v169
    v_pk_mul_f32 v[188:189], v[168:169], v[50:51] op_sel:[0,0] op_sel_hi:[0,1]
    ds_write_addtid_b32 v199 offset:4896
    ds_write_addtid_b32 v200 offset:4624
    v_pk_fma_f32 v[170:171], v[168:169], v[50:51], v[188:189] op_sel:[1,1,0] op_sel_hi:[1,0,1] neg_lo:[0,1,0]
    v_cvt_pk_bf16_f32 v200, v218, -v219
    ds_write_addtid_b32 v201 offset:2448
    v_cvt_pk_bf16_f32 v199, v170, -v171
    ds_write_addtid_b32 v202 offset:5984
    ds_write_addtid_b32 v203 offset:5712
    ds_write_addtid_b32 v196 offset:2720
    ds_write_addtid_b32 v197 offset:5168
    ds_write_addtid_b32 v198 offset:6256
    ds_write_addtid_b32 v199 offset:2992
    ds_write_addtid_b32 v200 offset:6528
    s_waitcnt vmcnt(2)
    s_nop 0
    ds_read_b128 v[112:115], v79 offset:0
    ds_read_b128 v[116:119], v79 offset:32
    ds_read_b128 v[120:123], v79 offset:64
    ds_read_b128 v[124:127], v79 offset:96
    ds_read_b128 v[128:131], v79 offset:128
    ds_read_b128 v[132:135], v79 offset:160
    ds_read_b128 v[136:139], v79 offset:192
    ds_read_b128 v[140:143], v79 offset:224
    v_and_b32 v20, 0xffff0000, v8
    v_and_b32 v21, 0xffff0000, v9
    v_and_b32 v22, 0xffff0000, v10
    v_and_b32 v23, 0xffff0000, v11
    v_and_b32 v24, 0xffff0000, v12
    v_and_b32 v25, 0xffff0000, v13
    s_waitcnt lgkmcnt(7)
    v_mfma_f32_32x32x16_bf16 v[144:159], v[112:115], v[80:83], 0
    v_mul_f32 v48, v20, v46
    v_mul_f32 v49, v21, v47
    v_mul_f32 v64, s38, v48
    v_mul_f32 v65, s38, v49
    v_mul_f32_e64 v66, s40, v48
    s_waitcnt lgkmcnt(6)
    v_mfma_f32_32x32x16_bf16 v[144:159], v[116:119], v[84:87], v[144:159]
    v_mul_f32 v67, s40, v49
    v_exp_f32 v190, v64
    v_fract_f32 v191, v65
    v_exp_f32_e64 v194, v66
    s_waitcnt lgkmcnt(5)
    v_mfma_f32_32x32x16_bf16 v[144:159], v[120:123], v[88:91], v[144:159]
    v_cos_f32 v56, v191
    v_sin_f32 v57, v191
    v_mul_f32 v56, v56, v190
    v_mul_f32_e64 v57, v57, v190
    s_waitcnt lgkmcnt(4)
    v_mfma_f32_32x32x16_bf16 v[144:159], v[124:127], v[92:95], v[144:159]
    v_mul_f32 v192, v56, v56
    v_mul_f32 v193, v56, v57
    v_fma_f32 v58, -v57, v57, v192
    v_fma_f32 v59, v57, v56, v193
    s_waitcnt lgkmcnt(3)
    v_mfma_f32_32x32x16_bf16 v[144:159], v[128:131], v[96:99], v[144:159]
    v_fract_f32 v195, v67
    v_exp_f32 v184, v48
    v_cos_f32 v60, v195
    v_sin_f32 v61, v195
    v_mul_f32_e64 v60, v60, v194
    s_waitcnt lgkmcnt(2)
    v_mfma_f32_32x32x16_bf16 v[144:159], v[132:135], v[100:103], v[144:159]
    v_mul_f32 v61, v61, v194
    v_fract_f32 v185, v49
    v_mul_f32 v186, v22, v24
    v_cos_f32_e64 v50, v185
    s_waitcnt lgkmcnt(1)
    v_mfma_f32_32x32x16_bf16 v[144:159], v[136:139], v[104:107], v[144:159]
    v_sin_f32 v51, v185
    v_mul_f32 v50, v50, v184
    v_mul_f32 v51, v51, v184
    v_mul_f32_e64 v187, v22, v25
    s_waitcnt lgkmcnt(0)
    v_mfma_f32_32x32x16_bf16 v[144:159], v[140:143], v[108:111], v[144:159]
    v_fma_f32 v62, -v23, v25, v186
    v_fma_f32 v63, v23, v24, v187
    v_mul_f32 v62, v62, v44
    v_mul_f32 v63, v63, v44
    ds_write_addtid_b32 v78 offset:0
    v_cvt_pk_bf16_f32 v201, v56, v57
    v_cvt_pk_bf16_f32 v202, v58, v59
    v_pk_mul_f32 v[188:189], v[56:57], v[58:59] op_sel:[0,0] op_sel_hi:[0,1]
    ds_write_addtid_b32 v201 offset:272
    v_pk_mul_f32 v[190:191], v[58:59], v[58:59] op_sel:[0,0] op_sel_hi:[0,1]
    v_pk_fma_f32 v[172:173], v[56:57], v[58:59], v[188:189] op_sel:[1,1,0] op_sel_hi:[1,0,1] neg_lo:[0,1,0]
    ds_write_addtid_b32 v202 offset:544
    v_pk_fma_f32 v[174:175], v[58:59], v[58:59], v[190:191] op_sel:[1,1,0] op_sel_hi:[1,0,1] neg_lo:[0,1,0]
    v_cvt_pk_bf16_f32 v203, v172, v173
    v_pk_mul_f32 v[192:193], v[172:173], v[58:59] op_sel:[0,0] op_sel_hi:[0,1]
    v_cvt_pk_bf16_f32 v196, v174, v175
    ds_write_addtid_b32 v203 offset:816
    v_pk_fma_f32 v[176:177], v[172:173], v[58:59], v[192:193] op_sel:[1,1,0] op_sel_hi:[1,0,1] neg_lo:[0,1,0]
    v_pk_mul_f32 v[194:195], v[174:175], v[58:59] op_sel:[0,0] op_sel_hi:[0,1]
    ds_write_addtid_b32 v196 offset:1088
    v_cvt_pk_bf16_f32 v197, v176, v177
    v_pk_fma_f32 v[178:179], v[174:175], v[58:59], v[194:195] op_sel:[1,1,0] op_sel_hi:[1,0,1] neg_lo:[0,1,0]
    v_pk_mul_f32 v[184:185], v[176:177], v[58:59] op_sel:[0,0] op_sel_hi:[0,1]
    ds_write_addtid_b32 v197 offset:1360
    v_cvt_pk_bf16_f32 v198, v178, v179
    v_pk_fma_f32 v[180:181], v[176:177], v[58:59], v[184:185] op_sel:[1,1,0] op_sel_hi:[1,0,1] neg_lo:[0,1,0]
    v_pk_mul_f32 v[186:187], v[178:179], v[58:59] op_sel:[0,0] op_sel_hi:[0,1]
    ds_write_addtid_b32 v198 offset:1632
    v_cvt_pk_bf16_f32 v199, v180, v181
    v_pk_fma_f32 v[182:183], v[178:179], v[58:59], v[186:187] op_sel:[1,1,0] op_sel_hi:[1,0,1] neg_lo:[0,1,0]
    v_pk_mul_f32 v[188:189], v[180:181], v[58:59] op_sel:[0,0] op_sel_hi:[0,1]
    ds_write_addtid_b32 v199 offset:1904
    v_cvt_pk_bf16_f32 v200, v182, v183
    v_pk_fma_f32 v[160:161], v[180:181], v[58:59], v[188:189] op_sel:[1,1,0] op_sel_hi:[1,0,1] neg_lo:[0,1,0]
    v_pk_mul_f32 v[190:191], v[182:183], v[58:59] op_sel:[0,0] op_sel_hi:[0,1]
    ds_write_addtid_b32 v200 offset:2176
    v_cvt_pk_bf16_f32 v201, v160, v161
    v_pk_fma_f32 v[162:163], v[182:183], v[58:59], v[190:191] op_sel:[1,1,0] op_sel_hi:[1,0,1] neg_lo:[0,1,0]
    v_pk_mul_f32 v[192:193], v[160:161], v[58:59] op_sel:[0,0] op_sel_hi:[0,1]
    ds_write_addtid_b32 v201 offset:2448
    v_cvt_pk_bf16_f32 v202, v162, v163
    v_pk_fma_f32 v[164:165], v[160:161], v[58:59], v[192:193] op_sel:[1,1,0] op_sel_hi:[1,0,1] neg_lo:[0,1,0]
    v_pk_mul_f32 v[194:195], v[162:163], v[58:59] op_sel:[0,0] op_sel_hi:[0,1]
    ds_write_addtid_b32 v202 offset:2720
    v_cvt_pk_bf16_f32 v203, v164, v165
    v_pk_fma_f32 v[166:167], v[162:163], v[58:59], v[194:195] op_sel:[1,1,0] op_sel_hi:[1,0,1] neg_lo:[0,1,0]
    v_pk_mul_f32 v[184:185], v[164:165], v[58:59] op_sel:[0,0] op_sel_hi:[0,1]
    ds_write_addtid_b32 v203 offset:2992
    v_cvt_pk_bf16_f32 v196, v166, v167
    v_pk_fma_f32 v[168:169], v[164:165], v[58:59], v[184:185] op_sel:[1,1,0] op_sel_hi:[1,0,1] neg_lo:[0,1,0]
    v_pk_mul_f32 v[186:187], v[166:167], v[58:59] op_sel:[0,0] op_sel_hi:[0,1]
    ds_write_addtid_b32 v196 offset:3264
    v_cvt_pk_bf16_f32 v197, v168, v169
    v_pk_fma_f32 v[170:171], v[166:167], v[58:59], v[186:187] op_sel:[1,1,0] op_sel_hi:[1,0,1] neg_lo:[0,1,0]
    v_pk_mul_f32 v[188:189], v[168:169], v[58:59] op_sel:[0,0] op_sel_hi:[0,1]
    ds_write_addtid_b32 v197 offset:3536
    v_cvt_pk_bf16_f32 v198, v170, v171
    v_pk_fma_f32 v[172:173], v[168:169], v[58:59], v[188:189] op_sel:[1,1,0] op_sel_hi:[1,0,1] neg_lo:[0,1,0]
    v_pk_mul_f32 v[190:191], v[170:171], v[58:59] op_sel:[0,0] op_sel_hi:[0,1]
    ds_write_addtid_b32 v198 offset:3808
    v_cvt_pk_bf16_f32 v199, v172, v173
    v_pk_fma_f32 v[174:175], v[170:171], v[58:59], v[190:191] op_sel:[1,1,0] op_sel_hi:[1,0,1] neg_lo:[0,1,0]
    v_pk_mul_f32 v[192:193], v[172:173], v[58:59] op_sel:[0,0] op_sel_hi:[0,1]
    ds_write_addtid_b32 v199 offset:4080
    v_cvt_pk_bf16_f32 v200, v174, v175
    v_pk_fma_f32 v[176:177], v[172:173], v[58:59], v[192:193] op_sel:[1,1,0] op_sel_hi:[1,0,1] neg_lo:[0,1,0]
    v_pk_mul_f32 v[194:195], v[174:175], v[58:59] op_sel:[0,0] op_sel_hi:[0,1]
    ds_write_addtid_b32 v200 offset:4352
    v_cvt_pk_bf16_f32 v201, v176, v177
    v_pk_fma_f32 v[178:179], v[174:175], v[58:59], v[194:195] op_sel:[1,1,0] op_sel_hi:[1,0,1] neg_lo:[0,1,0]
    v_pk_mul_f32 v[184:185], v[176:177], v[58:59] op_sel:[0,0] op_sel_hi:[0,1]
    ds_write_addtid_b32 v201 offset:4624
    v_cvt_pk_bf16_f32 v202, v178, v179
    v_pk_fma_f32 v[180:181], v[176:177], v[58:59], v[184:185] op_sel:[1,1,0] op_sel_hi:[1,0,1] neg_lo:[0,1,0]
    v_pk_mul_f32 v[186:187], v[178:179], v[58:59] op_sel:[0,0] op_sel_hi:[0,1]
    ds_write_addtid_b32 v202 offset:4896
    v_cvt_pk_bf16_f32 v203, v180, v181
    v_pk_fma_f32 v[182:183], v[178:179], v[58:59], v[186:187] op_sel:[1,1,0] op_sel_hi:[1,0,1] neg_lo:[0,1,0]
    v_pk_mul_f32 v[188:189], v[180:181], v[58:59] op_sel:[0,0] op_sel_hi:[0,1]
    ds_write_addtid_b32 v203 offset:5168
    v_cvt_pk_bf16_f32 v196, v182, v183
    v_pk_fma_f32 v[160:161], v[180:181], v[58:59], v[188:189] op_sel:[1,1,0] op_sel_hi:[1,0,1] neg_lo:[0,1,0]
    v_pk_mul_f32 v[190:191], v[182:183], v[58:59] op_sel:[0,0] op_sel_hi:[0,1]
    ds_write_addtid_b32 v196 offset:5440
    v_cvt_pk_bf16_f32 v197, v160, v161
    v_pk_fma_f32 v[162:163], v[182:183], v[58:59], v[190:191] op_sel:[1,1,0] op_sel_hi:[1,0,1] neg_lo:[0,1,0]
    v_pk_mul_f32 v[192:193], v[160:161], v[58:59] op_sel:[0,0] op_sel_hi:[0,1]
    ds_write_addtid_b32 v197 offset:5712
    v_cvt_pk_bf16_f32 v198, v162, v163
    v_pk_fma_f32 v[164:165], v[160:161], v[58:59], v[192:193] op_sel:[1,1,0] op_sel_hi:[1,0,1] neg_lo:[0,1,0]
    v_pk_mul_f32 v[194:195], v[162:163], v[58:59] op_sel:[0,0] op_sel_hi:[0,1]
    ds_write_addtid_b32 v198 offset:5984
    v_cvt_pk_bf16_f32 v199, v164, v165
    v_pk_fma_f32 v[166:167], v[162:163], v[58:59], v[194:195] op_sel:[1,1,0] op_sel_hi:[1,0,1] neg_lo:[0,1,0]
    v_pk_mul_f32 v[184:185], v[164:165], v[58:59] op_sel:[0,0] op_sel_hi:[0,1]
    ds_write_addtid_b32 v199 offset:6256
    v_cvt_pk_bf16_f32 v200, v166, v167
    v_pk_fma_f32 v[168:169], v[164:165], v[58:59], v[184:185] op_sel:[1,1,0] op_sel_hi:[1,0,1] neg_lo:[0,1,0]
    v_pk_mul_f32 v[186:187], v[166:167], v[58:59] op_sel:[0,0] op_sel_hi:[0,1]
    ds_write_addtid_b32 v200 offset:6528
    v_cvt_pk_bf16_f32 v201, v168, v169
    v_pk_fma_f32 v[170:171], v[166:167], v[58:59], v[186:187] op_sel:[1,1,0] op_sel_hi:[1,0,1] neg_lo:[0,1,0]
    v_pk_mul_f32 v[188:189], v[168:169], v[58:59] op_sel:[0,0] op_sel_hi:[0,1]
    ds_write_addtid_b32 v201 offset:6800
    v_cvt_pk_bf16_f32 v202, v170, v171
    v_pk_fma_f32 v[172:173], v[168:169], v[58:59], v[188:189] op_sel:[1,1,0] op_sel_hi:[1,0,1] neg_lo:[0,1,0]
    v_pk_mul_f32 v[190:191], v[170:171], v[58:59] op_sel:[0,0] op_sel_hi:[0,1]
    ds_write_addtid_b32 v202 offset:7072
    v_cvt_pk_bf16_f32 v203, v172, v173
    v_pk_fma_f32 v[174:175], v[170:171], v[58:59], v[190:191] op_sel:[1,1,0] op_sel_hi:[1,0,1] neg_lo:[0,1,0]
    v_pk_mul_f32 v[192:193], v[172:173], v[58:59] op_sel:[0,0] op_sel_hi:[0,1]
    ds_write_addtid_b32 v203 offset:7344
    v_cvt_pk_bf16_f32 v196, v174, v175
    v_pk_fma_f32 v[176:177], v[172:173], v[58:59], v[192:193] op_sel:[1,1,0] op_sel_hi:[1,0,1] neg_lo:[0,1,0]
    v_pk_mul_f32 v[194:195], v[174:175], v[58:59] op_sel:[0,0] op_sel_hi:[0,1]
    ds_write_addtid_b32 v196 offset:7616
    v_cvt_pk_bf16_f32 v197, v176, v177
    v_pk_fma_f32 v[178:179], v[174:175], v[58:59], v[194:195] op_sel:[1,1,0] op_sel_hi:[1,0,1] neg_lo:[0,1,0]
    v_pk_mul_f32 v[184:185], v[176:177], v[58:59] op_sel:[0,0] op_sel_hi:[0,1]
    ds_write_addtid_b32 v197 offset:7888
    v_cvt_pk_bf16_f32 v198, v178, v179
    v_pk_fma_f32 v[180:181], v[176:177], v[58:59], v[184:185] op_sel:[1,1,0] op_sel_hi:[1,0,1] neg_lo:[0,1,0]
    v_pk_mul_f32 v[186:187], v[50:51], v[50:51] op_sel:[0,0] op_sel_hi:[0,1]
    ds_write_addtid_b32 v198 offset:8160
    v_cvt_pk_bf16_f32 v199, v180, v181
    v_pk_fma_f32 v[52:53], v[50:51], v[50:51], v[186:187] op_sel:[1,1,0] op_sel_hi:[1,0,1] neg_lo:[0,1,0]
    v_pk_mul_f32 v[190:191], v[62:63], v[60:61] op_sel:[0,0] op_sel_hi:[0,1]
    ds_write_addtid_b32 v199 offset:8432
    v_pk_mul_f32 v[188:189], v[52:53], v[52:53] op_sel:[0,0] op_sel_hi:[0,1]
    v_pk_fma_f32 v[204:205], v[62:63], v[60:61], v[190:191] op_sel:[1,1,0] op_sel_hi:[1,0,1] neg_lo:[0,1,0]
    v_cvt_pk_bf16_f32 v200, v62, -v63
    ds_read_b128 v[80:83], v79 offset:0
    v_pk_fma_f32 v[54:55], v[52:53], v[52:53], v[188:189] op_sel:[1,1,0] op_sel_hi:[1,0,1] neg_lo:[0,1,0]
    v_pk_mul_f32 v[192:193], v[204:205], v[60:61] op_sel:[0,0] op_sel_hi:[0,1]
    v_cvt_pk_bf16_f32 v202, v204, -v205
    ds_read_b128 v[84:87], v79 offset:32
    v_pk_fma_f32 v[206:207], v[204:205], v[60:61], v[192:193] op_sel:[1,1,0] op_sel_hi:[1,0,1] neg_lo:[0,1,0]
    ds_read_b128 v[88:91], v79 offset:64
    ds_read_b128 v[92:95], v79 offset:96
    v_pk_mul_f32 v[194:195], v[206:207], v[60:61] op_sel:[0,0] op_sel_hi:[0,1]
    v_cvt_pk_bf16_f32 v197, v206, -v207
    ds_read_b128 v[96:99], v79 offset:128
    v_pk_fma_f32 v[208:209], v[206:207], v[60:61], v[194:195] op_sel:[1,1,0] op_sel_hi:[1,0,1] neg_lo:[0,1,0]
    v_pk_mul_f32 v[194:195], v[62:63], v[50:51] op_sel:[0,0] op_sel_hi:[0,1]
    ds_read_b128 v[100:103], v79 offset:160
    v_pk_mul_f32 v[184:185], v[208:209], v[60:61] op_sel:[0,0] op_sel_hi:[0,1]
    v_pk_fma_f32 v[182:183], v[62:63], v[50:51], v[194:195] op_sel:[1,1,0] op_sel_hi:[1,0,1] neg_lo:[0,1,0]
    ds_read_b128 v[104:107], v79 offset:192
    v_pk_fma_f32 v[210:211], v[208:209], v[60:61], v[184:185] op_sel:[1,1,0] op_sel_hi:[1,0,1] neg_lo:[0,1,0]
    v_cvt_pk_bf16_f32 v201, v182, -v183
    v_pk_mul_f32 v[184:185], v[204:205], v[52:53] op_sel:[0,0] op_sel_hi:[0,1]
    ds_read_b128 v[108:111], v79 offset:224
    v_pk_mul_f32 v[186:187], v[210:211], v[60:61] op_sel:[0,0] op_sel_hi:[0,1]
PG_A1:
    s_cbranch_execz PG_A2
    s_nop 0
    v_pk_fma_f32 v[160:161], v[204:205], v[52:53], v[184:185] op_sel:[1,1,0] op_sel_hi:[1,0,1] neg_lo:[0,1,0]
    v_pk_mul_f32 v[184:185], v[206:207], v[54:55] op_sel:[0,0] op_sel_hi:[0,1]
    ds_write_addtid_b32 v200 offset:0
    v_pk_fma_f32 v[212:213], v[210:211], v[60:61], v[186:187] op_sel:[1,1,0] op_sel_hi:[1,0,1] neg_lo:[0,1,0]
    v_cvt_pk_bf16_f32 v203, v160, -v161
    v_pk_mul_f32 v[186:187], v[182:183], v[50:51] op_sel:[0,0] op_sel_hi:[0,1]
    ds_write_addtid_b32 v201 offset:272
    v_pk_mul_f32 v[188:189], v[212:213], v[60:61] op_sel:[0,0] op_sel_hi:[0,1]
    v_pk_fma_f32 v[162:163], v[182:183], v[50:51], v[186:187] op_sel:[1,1,0] op_sel_hi:[1,0,1] neg_lo:[0,1,0]
    v_cvt_pk_bf16_f32 v200, v208, -v209
    ds_write_addtid_b32 v202 offset:1088
    v_pk_fma_f32 v[214:215], v[212:213], v[60:61], v[188:189] op_sel:[1,1,0] op_sel_hi:[1,0,1] neg_lo:[0,1,0]
    v_cvt_pk_bf16_f32 v196, v162, -v163
    v_pk_mul_f32 v[188:189], v[160:161], v[52:53] op_sel:[0,0] op_sel_hi:[0,1]
    ds_write_addtid_b32 v202 offset:1360
    v_pk_mul_f32 v[190:191], v[214:215], v[60:61] op_sel:[0,0] op_sel_hi:[0,1]
    v_pk_fma_f32 v[164:165], v[160:161], v[52:53], v[188:189] op_sel:[1,1,0] op_sel_hi:[1,0,1] neg_lo:[0,1,0]
    v_pk_fma_f32 v[172:173], v[206:207], v[54:55], v[184:185] op_sel:[1,1,0] op_sel_hi:[1,0,1] neg_lo:[0,1,0]
    ds_write_addtid_b32 v203 offset:1632
    v_pk_fma_f32 v[216:217], v[214:215], v[60:61], v[190:191] op_sel:[1,1,0] op_sel_hi:[1,0,1] neg_lo:[0,1,0]
    v_cvt_pk_bf16_f32 v198, v164, -v165
    v_pk_mul_f32 v[190:191], v[162:163], v[50:51] op_sel:[0,0] op_sel_hi:[0,1]
    ds_write_addtid_b32 v196 offset:544
    v_pk_mul_f32 v[192:193], v[216:217], v[60:61] op_sel:[0,0] op_sel_hi:[0,1]
    v_pk_fma_f32 v[166:167], v[162:163], v[50:51], v[190:191] op_sel:[1,1,0] op_sel_hi:[1,0,1] neg_lo:[0,1,0]
    v_cvt_pk_bf16_f32 v203, v210, -v211
    ds_write_addtid_b32 v197 offset:4352
    v_pk_fma_f32 v[218:219], v[216:217], v[60:61], v[192:193] op_sel:[1,1,0] op_sel_hi:[1,0,1] neg_lo:[0,1,0]
    v_cvt_pk_bf16_f32 v199, v166, -v167
    v_pk_mul_f32 v[192:193], v[164:165], v[52:53] op_sel:[0,0] op_sel_hi:[0,1]
    ds_write_addtid_b32 v198 offset:1904
    v_pk_mul_f32 v[194:195], v[166:167], v[50:51] op_sel:[0,0] op_sel_hi:[0,1]
    v_pk_fma_f32 v[168:169], v[164:165], v[52:53], v[192:193] op_sel:[1,1,0] op_sel_hi:[1,0,1] neg_lo:[0,1,0]
    v_cvt_pk_bf16_f32 v196, v172, -v173
    ds_write_addtid_b32 v198 offset:3264
    v_cvt_pk_bf16_f32 v201, v168, -v169
    v_pk_fma_f32 v[170:171], v[166:167], v[50:51], v[194:195] op_sel:[1,1,0] op_sel_hi:[1,0,1] neg_lo:[0,1,0]
    v_pk_mul_f32 v[188:189], v[208:209], v[54:55] op_sel:[0,0] op_sel_hi:[0,1]
    ds_write_addtid_b32 v198 offset:3536
    v_cvt_pk_bf16_f32 v202, v170, -v171
    v_pk_mul_f32 v[186:187], v[170:171], v[50:51] op_sel:[0,0] op_sel_hi:[0,1]
    v_cvt_pk_bf16_f32 v198, v212, -v213
    ds_write_addtid_b32 v199 offset:816
    v_pk_fma_f32 v[174:175], v[170:171], v[50:51], v[186:187] op_sel:[1,1,0] op_sel_hi:[1,0,1] neg_lo:[0,1,0]
    v_pk_fma_f32 v[176:177], v[208:209], v[54:55], v[188:189] op_sel:[1,1,0] op_sel_hi:[1,0,1] neg_lo:[0,1,0]
    ds_write_addtid_b32 v200 offset:5440
    v_cvt_pk_bf16_f32 v197, v174, -v175
    v_cvt_pk_bf16_f32 v199, v176, -v177
    v_pk_mul_f32 v[190:191], v[174:175], v[50:51] op_sel:[0,0] op_sel_hi:[0,1]
    ds_write_addtid_b32 v201 offset:3808
    v_cvt_pk_bf16_f32 v201, v214, -v215
    v_pk_fma_f32 v[178:179], v[174:175], v[50:51], v[190:191] op_sel:[1,1,0] op_sel_hi:[1,0,1] neg_lo:[0,1,0]
    ds_write_addtid_b32 v202 offset:2176
    v_cvt_pk_bf16_f32 v202, v216, -v217
    v_cvt_pk_bf16_f32 v200, v178, -v179
    v_pk_mul_f32 v[192:193], v[178:179], v[50:51] op_sel:[0,0] op_sel_hi:[0,1]
    ds_write_addtid_b32 v203 offset:4896
    ds_write_addtid_b32 v196 offset:4624
    v_pk_fma_f32 v[180:181], v[178:179], v[50:51], v[192:193] op_sel:[1,1,0] op_sel_hi:[1,0,1] neg_lo:[0,1,0]
    v_cvt_pk_bf16_f32 v196, v218, -v219
    ds_write_addtid_b32 v197 offset:2448
    v_cvt_pk_bf16_f32 v203, v180, -v181
    ds_write_addtid_b32 v198 offset:5984
    ds_write_addtid_b32 v199 offset:5712
    ds_write_addtid_b32 v200 offset:2720
    ds_write_addtid_b32 v201 offset:5168
    ds_write_addtid_b32 v202 offset:6256
    ds_write_addtid_b32 v203 offset:2992
    ds_write_addtid_b32 v196 offset:6528
    ds_read_b128 v[112:115], v79 offset:0
    ds_read_b128 v[116:119], v79 offset:32
    ds_read_b128 v[120:123], v79 offset:64
    ds_read_b128 v[124:127], v79 offset:96
    ds_read_b128 v[128:131], v79 offset:128
    ds_read_b128 v[132:135], v79 offset:160
    ds_read_b128 v[136:139], v79 offset:192
    ds_read_b128 v[140:143], v79 offset:224
    v_mul_f32 v48, v14, v46
    v_mul_f32 v49, v15, v47
    v_mul_f32 v64, s38, v48
    v_mul_f32 v65, s38, v49
    v_mul_f32 v66, s40, v48
    v_mul_f32_e64 v67, s40, v49
    s_waitcnt lgkmcnt(7)
    v_mfma_f32_32x32x16_bf16 v[144:159], v[112:115], v[80:83], v[144:159]
    v_exp_f32 v194, v64
    v_fract_f32 v195, v65
    v_exp_f32 v186, v66
    v_cos_f32_e64 v56, v195
    s_waitcnt lgkmcnt(6)
    v_mfma_f32_32x32x16_bf16 v[144:159], v[116:119], v[84:87], v[144:159]
    v_sin_f32 v57, v195
    v_mul_f32 v56, v56, v194
    v_mul_f32 v57, v57, v194
    s_waitcnt lgkmcnt(5)
    v_mfma_f32_32x32x16_bf16 v[144:159], v[120:123], v[88:91], v[144:159]
    v_mul_f32 v184, v56, v56
    v_mul_f32 v185, v56, v57
    v_fma_f32 v58, -v57, v57, v184
    v_fma_f32 v59, v57, v56, v185
    s_waitcnt lgkmcnt(4)
    v_mfma_f32_32x32x16_bf16 v[144:159], v[124:127], v[92:95], v[144:159]
    v_fract_f32 v187, v67
    v_exp_f32 v188, v48
    v_cos_f32_e64 v60, v187
    s_waitcnt lgkmcnt(3)
    v_mfma_f32_32x32x16_bf16 v[144:159], v[128:131], v[96:99], v[144:159]
    v_sin_f32 v61, v187
    v_mul_f32 v60, v60, v186
    v_mul_f32 v61, v61, v186
    v_fract_f32_e64 v189, v49
    s_waitcnt lgkmcnt(2)
    v_mfma_f32_32x32x16_bf16 v[144:159], v[132:135], v[100:103], v[144:159]
    v_mul_f32 v190, v16, v18
    v_cos_f32 v50, v189
    v_sin_f32 v51, v189
    s_waitcnt lgkmcnt(1)
    v_mfma_f32_32x32x16_bf16 v[144:159], v[136:139], v[104:107], v[144:159]
    v_mul_f32 v50, v50, v188
    v_mul_f32 v51, v51, v188
    v_mul_f32_e64 v191, v16, v19
    v_fma_f32 v62, -v17, v19, v190
    s_waitcnt lgkmcnt(0)
    v_mfma_f32_32x32x16_bf16 v[144:159], v[140:143], v[108:111], v[144:159]
    v_fma_f32 v63, v17, v18, v191
    v_mul_f32 v62, v62, v44
    v_mul_f32_e64 v63, v63, v44
    ds_write_addtid_b32 v78 offset:0
    v_cvt_pk_bf16_f32 v197, v56, v57
    v_cvt_pk_bf16_f32 v198, v58, v59
    v_pk_mul_f32 v[192:193], v[56:57], v[58:59] op_sel:[0,0] op_sel_hi:[0,1]
    ds_write_addtid_b32 v197 offset:272
    v_pk_mul_f32 v[194:195], v[58:59], v[58:59] op_sel:[0,0] op_sel_hi:[0,1]
    v_pk_fma_f32 v[182:183], v[56:57], v[58:59], v[192:193] op_sel:[1,1,0] op_sel_hi:[1,0,1] neg_lo:[0,1,0]
    ds_write_addtid_b32 v198 offset:544
    v_pk_fma_f32 v[160:161], v[58:59], v[58:59], v[194:195] op_sel:[1,1,0] op_sel_hi:[1,0,1] neg_lo:[0,1,0]
    v_cvt_pk_bf16_f32 v199, v182, v183
    v_pk_mul_f32 v[184:185], v[182:183], v[58:59] op_sel:[0,0] op_sel_hi:[0,1]
    v_cvt_pk_bf16_f32 v200, v160, v161
    ds_write_addtid_b32 v199 offset:816
    v_pk_fma_f32 v[162:163], v[182:183], v[58:59], v[184:185] op_sel:[1,1,0] op_sel_hi:[1,0,1] neg_lo:[0,1,0]
    v_pk_mul_f32 v[186:187], v[160:161], v[58:59] op_sel:[0,0] op_sel_hi:[0,1]
    ds_write_addtid_b32 v200 offset:1088
    v_cvt_pk_bf16_f32 v201, v162, v163
    v_pk_fma_f32 v[164:165], v[160:161], v[58:59], v[186:187] op_sel:[1,1,0] op_sel_hi:[1,0,1] neg_lo:[0,1,0]
    v_pk_mul_f32 v[188:189], v[162:163], v[58:59] op_sel:[0,0] op_sel_hi:[0,1]
    ds_write_addtid_b32 v201 offset:1360
    v_cvt_pk_bf16_f32 v202, v164, v165
    v_pk_fma_f32 v[166:167], v[162:163], v[58:59], v[188:189] op_sel:[1,1,0] op_sel_hi:[1,0,1] neg_lo:[0,1,0]
    v_pk_mul_f32 v[190:191], v[164:165], v[58:59] op_sel:[0,0] op_sel_hi:[0,1]
    ds_write_addtid_b32 v202 offset:1632
    v_cvt_pk_bf16_f32 v203, v166, v167
    v_pk_fma_f32 v[168:169], v[164:165], v[58:59], v[190:191] op_sel:[1,1,0] op_sel_hi:[1,0,1] neg_lo:[0,1,0]
    v_pk_mul_f32 v[192:193], v[166:167], v[58:59] op_sel:[0,0] op_sel_hi:[0,1]
    ds_write_addtid_b32 v203 offset:1904
    v_cvt_pk_bf16_f32 v196, v168, v169
    v_pk_fma_f32 v[170:171], v[166:167], v[58:59], v[192:193] op_sel:[1,1,0] op_sel_hi:[1,0,1] neg_lo:[0,1,0]
    v_pk_mul_f32 v[194:195], v[168:169], v[58:59] op_sel:[0,0] op_sel_hi:[0,1]
    ds_write_addtid_b32 v196 offset:2176
    v_cvt_pk_bf16_f32 v197, v170, v171
    v_pk_fma_f32 v[172:173], v[168:169], v[58:59], v[194:195] op_sel:[1,1,0] op_sel_hi:[1,0,1] neg_lo:[0,1,0]
    v_pk_mul_f32 v[184:185], v[170:171], v[58:59] op_sel:[0,0] op_sel_hi:[0,1]
    ds_write_addtid_b32 v197 offset:2448
    v_cvt_pk_bf16_f32 v198, v172, v173
    v_pk_fma_f32 v[174:175], v[170:171], v[58:59], v[184:185] op_sel:[1,1,0] op_sel_hi:[1,0,1] neg_lo:[0,1,0]
    v_pk_mul_f32 v[186:187], v[172:173], v[58:59] op_sel:[0,0] op_sel_hi:[0,1]
    ds_write_addtid_b32 v198 offset:2720
    v_cvt_pk_bf16_f32 v199, v174, v175
    v_pk_fma_f32 v[176:177], v[172:173], v[58:59], v[186:187] op_sel:[1,1,0] op_sel_hi:[1,0,1] neg_lo:[0,1,0]
    v_pk_mul_f32 v[188:189], v[174:175], v[58:59] op_sel:[0,0] op_sel_hi:[0,1]
    ds_write_addtid_b32 v199 offset:2992
    v_cvt_pk_bf16_f32 v200, v176, v177
    v_pk_fma_f32 v[178:179], v[174:175], v[58:59], v[188:189] op_sel:[1,1,0] op_sel_hi:[1,0,1] neg_lo:[0,1,0]
    v_pk_mul_f32 v[190:191], v[176:177], v[58:59] op_sel:[0,0] op_sel_hi:[0,1]
    ds_write_addtid_b32 v200 offset:3264
    v_cvt_pk_bf16_f32 v201, v178, v179
    v_pk_fma_f32 v[180:181], v[176:177], v[58:59], v[190:191] op_sel:[1,1,0] op_sel_hi:[1,0,1] neg_lo:[0,1,0]
    v_pk_mul_f32 v[192:193], v[178:179], v[58:59] op_sel:[0,0] op_sel_hi:[0,1]
    ds_write_addtid_b32 v201 offset:3536
    v_cvt_pk_bf16_f32 v202, v180, v181
    v_pk_fma_f32 v[182:183], v[178:179], v[58:59], v[192:193] op_sel:[1,1,0] op_sel_hi:[1,0,1] neg_lo:[0,1,0]
    v_pk_mul_f32 v[194:195], v[180:181], v[58:59] op_sel:[0,0] op_sel_hi:[0,1]
    ds_write_addtid_b32 v202 offset:3808
    v_cvt_pk_bf16_f32 v203, v182, v183
    v_pk_fma_f32 v[160:161], v[180:181], v[58:59], v[194:195] op_sel:[1,1,0] op_sel_hi:[1,0,1] neg_lo:[0,1,0]
    v_pk_mul_f32 v[184:185], v[182:183], v[58:59] op_sel:[0,0] op_sel_hi:[0,1]
    ds_write_addtid_b32 v203 offset:4080
    v_cvt_pk_bf16_f32 v196, v160, v161
    v_pk_fma_f32 v[162:163], v[182:183], v[58:59], v[184:185] op_sel:[1,1,0] op_sel_hi:[1,0,1] neg_lo:[0,1,0]
    v_pk_mul_f32 v[186:187], v[160:161], v[58:59] op_sel:[0,0] op_sel_hi:[0,1]
    ds_write_addtid_b32 v196 offset:4352
    v_cvt_pk_bf16_f32 v197, v162, v163
    v_pk_fma_f32 v[164:165], v[160:161], v[58:59], v[186:187] op_sel:[1,1,0] op_sel_hi:[1,0,1] neg_lo:[0,1,0]
    v_pk_mul_f32 v[188:189], v[162:163], v[58:59] op_sel:[0,0] op_sel_hi:[0,1]
    ds_write_addtid_b32 v197 offset:4624
    v_cvt_pk_bf16_f32 v198, v164, v165
    v_pk_fma_f32 v[166:167], v[162:163], v[58:59], v[188:189] op_sel:[1,1,0] op_sel_hi:[1,0,1] neg_lo:[0,1,0]
    v_pk_mul_f32 v[190:191], v[164:165], v[58:59] op_sel:[0,0] op_sel_hi:[0,1]
    ds_write_addtid_b32 v198 offset:4896
    v_cvt_pk_bf16_f32 v199, v166, v167
    v_pk_fma_f32 v[168:169], v[164:165], v[58:59], v[190:191] op_sel:[1,1,0] op_sel_hi:[1,0,1] neg_lo:[0,1,0]
    v_pk_mul_f32 v[192:193], v[166:167], v[58:59] op_sel:[0,0] op_sel_hi:[0,1]
    ds_write_addtid_b32 v199 offset:5168
    v_cvt_pk_bf16_f32 v200, v168, v169
    v_pk_fma_f32 v[170:171], v[166:167], v[58:59], v[192:193] op_sel:[1,1,0] op_sel_hi:[1,0,1] neg_lo:[0,1,0]
    v_pk_mul_f32 v[194:195], v[168:169], v[58:59] op_sel:[0,0] op_sel_hi:[0,1]
    ds_write_addtid_b32 v200 offset:5440
    v_cvt_pk_bf16_f32 v201, v170, v171
    v_pk_fma_f32 v[172:173], v[168:169], v[58:59], v[194:195] op_sel:[1,1,0] op_sel_hi:[1,0,1] neg_lo:[0,1,0]
    v_pk_mul_f32 v[184:185], v[170:171], v[58:59] op_sel:[0,0] op_sel_hi:[0,1]
    ds_write_addtid_b32 v201 offset:5712
    v_cvt_pk_bf16_f32 v202, v172, v173
    v_pk_fma_f32 v[174:175], v[170:171], v[58:59], v[184:185] op_sel:[1,1,0] op_sel_hi:[1,0,1] neg_lo:[0,1,0]
    v_pk_mul_f32 v[186:187], v[172:173], v[58:59] op_sel:[0,0] op_sel_hi:[0,1]
    ds_write_addtid_b32 v202 offset:5984
    v_cvt_pk_bf16_f32 v203, v174, v175
    v_pk_fma_f32 v[176:177], v[172:173], v[58:59], v[186:187] op_sel:[1,1,0] op_sel_hi:[1,0,1] neg_lo:[0,1,0]
    v_pk_mul_f32 v[188:189], v[174:175], v[58:59] op_sel:[0,0] op_sel_hi:[0,1]
    ds_write_addtid_b32 v203 offset:6256
    v_cvt_pk_bf16_f32 v196, v176, v177
    v_pk_fma_f32 v[178:179], v[174:175], v[58:59], v[188:189] op_sel:[1,1,0] op_sel_hi:[1,0,1] neg_lo:[0,1,0]
    v_pk_mul_f32 v[190:191], v[176:177], v[58:59] op_sel:[0,0] op_sel_hi:[0,1]
    ds_write_addtid_b32 v196 offset:6528
    v_cvt_pk_bf16_f32 v197, v178, v179
    v_pk_fma_f32 v[180:181], v[176:177], v[58:59], v[190:191] op_sel:[1,1,0] op_sel_hi:[1,0,1] neg_lo:[0,1,0]
    v_pk_mul_f32 v[192:193], v[178:179], v[58:59] op_sel:[0,0] op_sel_hi:[0,1]
    ds_write_addtid_b32 v197 offset:6800
    v_cvt_pk_bf16_f32 v198, v180, v181
    v_pk_fma_f32 v[182:183], v[178:179], v[58:59], v[192:193] op_sel:[1,1,0] op_sel_hi:[1,0,1] neg_lo:[0,1,0]
    v_pk_mul_f32 v[194:195], v[180:181], v[58:59] op_sel:[0,0] op_sel_hi:[0,1]
    ds_write_addtid_b32 v198 offset:7072
    v_cvt_pk_bf16_f32 v199, v182, v183
    v_pk_fma_f32 v[160:161], v[180:181], v[58:59], v[194:195] op_sel:[1,1,0] op_sel_hi:[1,0,1] neg_lo:[0,1,0]
    v_pk_mul_f32 v[184:185], v[182:183], v[58:59] op_sel:[0,0] op_sel_hi:[0,1]
    ds_write_addtid_b32 v199 offset:7344
    v_cvt_pk_bf16_f32 v200, v160, v161
    s_cmp_lg_u32 s45, 1
    s_cbranch_scc1 A_NOU10
    s_add_u32 m0, s68, 0
    s_nop 0
    buffer_load_dwordx4 v241, s[52:55], s66 offen lds
    s_add_u32 m0, s69, 0
    s_nop 0
    buffer_load_dwordx4 v241, s[52:55], s67 offen lds
    s_mov_b32 m0, s32
    s_nop 0
A_NOU10:
    v_pk_fma_f32 v[162:163], v[182:183], v[58:59], v[184:185] op_sel:[1,1,0] op_sel_hi:[1,0,1] neg_lo:[0,1,0]
    v_pk_mul_f32 v[186:187], v[160:161], v[58:59] op_sel:[0,0] op_sel_hi:[0,1]
    ds_write_addtid_b32 v200 offset:7616
    v_cvt_pk_bf16_f32 v201, v162, v163
    v_pk_fma_f32 v[164:165], v[160:161], v[58:59], v[186:187] op_sel:[1,1,0] op_sel_hi:[1,0,1] neg_lo:[0,1,0]
    v_pk_mul_f32 v[188:189], v[162:163], v[58:59] op_sel:[0,0] op_sel_hi:[0,1]
    ds_write_addtid_b32 v201 offset:7888
    v_cvt_pk_bf16_f32 v202, v164, v165
    v_pk_fma_f32 v[166:167], v[162:163], v[58:59], v[188:189] op_sel:[1,1,0] op_sel_hi:[1,0,1] neg_lo:[0,1,0]
    v_pk_mul_f32 v[190:191], v[50:51], v[50:51] op_sel:[0,0] op_sel_hi:[0,1]
    ds_write_addtid_b32 v202 offset:8160
    v_cvt_pk_bf16_f32 v203, v166, v167
    v_pk_fma_f32 v[52:53], v[50:51], v[50:51], v[190:191] op_sel:[1,1,0] op_sel_hi:[1,0,1] neg_lo:[0,1,0]
    v_pk_mul_f32 v[194:195], v[62:63], v[60:61] op_sel:[0,0] op_sel_hi:[0,1]
    ds_write_addtid_b32 v203 offset:8432
    v_pk_mul_f32 v[192:193], v[52:53], v[52:53] op_sel:[0,0] op_sel_hi:[0,1]
    v_pk_fma_f32 v[204:205], v[62:63], v[60:61], v[194:195] op_sel:[1,1,0] op_sel_hi:[1,0,1] neg_lo:[0,1,0]
    v_cvt_pk_bf16_f32 v196, v62, -v63
    ds_read_b128 v[80:83], v79 offset:0
    v_pk_fma_f32 v[54:55], v[52:53], v[52:53], v[192:193] op_sel:[1,1,0] op_sel_hi:[1,0,1] neg_lo:[0,1,0]
    v_pk_mul_f32 v[184:185], v[204:205], v[60:61] op_sel:[0,0] op_sel_hi:[0,1]
    v_cvt_pk_bf16_f32 v198, v204, -v205
    ds_read_b128 v[84:87], v79 offset:32
    v_pk_fma_f32 v[206:207], v[204:205], v[60:61], v[184:185] op_sel:[1,1,0] op_sel_hi:[1,0,1] neg_lo:[0,1,0]
    ds_read_b128 v[88:91], v79 offset:64
    ds_read_b128 v[92:95], v79 offset:96
    v_pk_mul_f32 v[186:187], v[206:207], v[60:61] op_sel:[0,0] op_sel_hi:[0,1]
    v_cvt_pk_bf16_f32 v201, v206, -v207
    ds_read_b128 v[96:99], v79 offset:128
    v_pk_fma_f32 v[208:209], v[206:207], v[60:61], v[186:187] op_sel:[1,1,0] op_sel_hi:[1,0,1] neg_lo:[0,1,0]
    v_pk_mul_f32 v[186:187], v[62:63], v[50:51] op_sel:[0,0] op_sel_hi:[0,1]
    ds_read_b128 v[100:103], v79 offset:160
    v_pk_mul_f32 v[188:189], v[208:209], v[60:61] op_sel:[0,0] op_sel_hi:[0,1]
    v_pk_fma_f32 v[168:169], v[62:63], v[50:51], v[186:187] op_sel:[1,1,0] op_sel_hi:[1,0,1] neg_lo:[0,1,0]
    ds_read_b128 v[104:107], v79 offset:192
    v_pk_fma_f32 v[210:211], v[208:209], v[60:61], v[188:189] op_sel:[1,1,0] op_sel_hi:[1,0,1] neg_lo:[0,1,0]
    v_cvt_pk_bf16_f32 v197, v168, -v169
    v_pk_mul_f32 v[188:189], v[204:205], v[52:53] op_sel:[0,0] op_sel_hi:[0,1]
    ds_read_b128 v[108:111], v79 offset:224
    v_pk_mul_f32 v[190:191], v[210:211], v[60:61] op_sel:[0,0] op_sel_hi:[0,1]
    v_pk_fma_f32 v[170:171], v[204:205], v[52:53], v[188:189] op_sel:[1,1,0] op_sel_hi:[1,0,1] neg_lo:[0,1,0]
    v_pk_mul_f32 v[188:189], v[206:207], v[54:55] op_sel:[0,0] op_sel_hi:[0,1]
    ds_write_addtid_b32 v196 offset:0
    v_pk_fma_f32 v[212:213], v[210:211], v[60:61], v[190:191] op_sel:[1,1,0] op_sel_hi:[1,0,1] neg_lo:[0,1,0]
    v_cvt_pk_bf16_f32 v199, v170, -v171
    v_pk_mul_f32 v[190:191], v[168:169], v[50:51] op_sel:[0,0] op_sel_hi:[0,1]
    ds_write_addtid_b32 v197 offset:272
    v_pk_mul_f32 v[192:193], v[212:213], v[60:61] op_sel:[0,0] op_sel_hi:[0,1]
    v_pk_fma_f32 v[172:173], v[168:169], v[50:51], v[190:191] op_sel:[1,1,0] op_sel_hi:[1,0,1] neg_lo:[0,1,0]
    v_cvt_pk_bf16_f32 v196, v208, -v209
    ds_write_addtid_b32 v198 offset:1088
    v_pk_fma_f32 v[214:215], v[212:213], v[60:61], v[192:193] op_sel:[1,1,0] op_sel_hi:[1,0,1] neg_lo:[0,1,0]
    v_cvt_pk_bf16_f32 v200, v172, -v173
    v_pk_mul_f32 v[192:193], v[170:171], v[52:53] op_sel:[0,0] op_sel_hi:[0,1]
    ds_write_addtid_b32 v198 offset:1360
    v_pk_mul_f32 v[194:195], v[214:215], v[60:61] op_sel:[0,0] op_sel_hi:[0,1]
    v_pk_fma_f32 v[174:175], v[170:171], v[52:53], v[192:193] op_sel:[1,1,0] op_sel_hi:[1,0,1] neg_lo:[0,1,0]
    v_pk_fma_f32 v[182:183], v[206:207], v[54:55], v[188:189] op_sel:[1,1,0] op_sel_hi:[1,0,1] neg_lo:[0,1,0]
    ds_write_addtid_b32 v199 offset:1632
    v_pk_fma_f32 v[216:217], v[214:215], v[60:61], v[194:195] op_sel:[1,1,0] op_sel_hi:[1,0,1] neg_lo:[0,1,0]
    v_cvt_pk_bf16_f32 v202, v174, -v175
    v_pk_mul_f32 v[194:195], v[172:173], v[50:51] op_sel:[0,0] op_sel_hi:[0,1]
    ds_write_addtid_b32 v200 offset:544
    v_pk_mul_f32 v[184:185], v[216:217], v[60:61] op_sel:[0,0] op_sel_hi:[0,1]
    v_pk_fma_f32 v[176:177], v[172:173], v[50:51], v[194:195] op_sel:[1,1,0] op_sel_hi:[1,0,1] neg_lo:[0,1,0]
    v_cvt_pk_bf16_f32 v199, v210, -v211
    ds_write_addtid_b32 v201 offset:4352
    v_pk_fma_f32 v[218:219], v[216:217], v[60:61], v[184:185] op_sel:[1,1,0] op_sel_hi:[1,0,1] neg_lo:[0,1,0]
    v_cvt_pk_bf16_f32 v203, v176, -v177
    v_pk_mul_f32 v[184:185], v[174:175], v[52:53] op_sel:[0,0] op_sel_hi:[0,1]
    ds_write_addtid_b32 v202 offset:1904
    v_pk_mul_f32 v[186:187], v[176:177], v[50:51] op_sel:[0,0] op_sel_hi:[0,1]
    v_pk_fma_f32 v[178:179], v[174:175], v[52:53], v[184:185] op_sel:[1,1,0] op_sel_hi:[1,0,1] neg_lo:[0,1,0]
    v_cvt_pk_bf16_f32 v200, v182, -v183
    ds_write_addtid_b32 v202 offset:3264
    v_cvt_pk_bf16_f32 v197, v178, -v179
    v_pk_fma_f32 v[180:181], v[176:177], v[50:51], v[186:187] op_sel:[1,1,0] op_sel_hi:[1,0,1] neg_lo:[0,1,0]
    v_pk_mul_f32 v[192:193], v[208:209], v[54:55] op_sel:[0,0] op_sel_hi:[0,1]
    ds_write_addtid_b32 v202 offset:3536
    v_cvt_pk_bf16_f32 v198, v180, -v181
    v_pk_mul_f32 v[190:191], v[180:181], v[50:51] op_sel:[0,0] op_sel_hi:[0,1]
    v_cvt_pk_bf16_f32 v202, v212, -v213
    ds_write_addtid_b32 v203 offset:816
    v_pk_fma_f32 v[160:161], v[180:181], v[50:51], v[190:191] op_sel:[1,1,0] op_sel_hi:[1,0,1] neg_lo:[0,1,0]
    v_pk_fma_f32 v[162:163], v[208:209], v[54:55], v[192:193] op_sel:[1,1,0] op_sel_hi:[1,0,1] neg_lo:[0,1,0]
    ds_write_addtid_b32 v196 offset:5440
    v_cvt_pk_bf16_f32 v201, v160, -v161
    v_cvt_pk_bf16_f32 v203, v162, -v163
    v_pk_mul_f32 v[194:195], v[160:161], v[50:51] op_sel:[0,0] op_sel_hi:[0,1]
    ds_write_addtid_b32 v197 offset:3808
    v_cvt_pk_bf16_f32 v197, v214, -v215
    v_pk_fma_f32 v[164:165], v[160:161], v[50:51], v[194:195] op_sel:[1,1,0] op_sel_hi:[1,0,1] neg_lo:[0,1,0]
    ds_write_addtid_b32 v198 offset:2176
    v_cvt_pk_bf16_f32 v198, v216, -v217
    v_cvt_pk_bf16_f32 v196, v164, -v165
    v_pk_mul_f32 v[184:185], v[164:165], v[50:51] op_sel:[0,0] op_sel_hi:[0,1]
    ds_write_addtid_b32 v199 offset:4896
    ds_write_addtid_b32 v200 offset:4624
    v_pk_fma_f32 v[166:167], v[164:165], v[50:51], v[184:185] op_sel:[1,1,0] op_sel_hi:[1,0,1] neg_lo:[0,1,0]
    v_cvt_pk_bf16_f32 v200, v218, -v219
    ds_write_addtid_b32 v201 offset:2448
    v_cvt_pk_bf16_f32 v199, v166, -v167
    ds_write_addtid_b32 v202 offset:5984
    ds_write_addtid_b32 v203 offset:5712
    ds_write_addtid_b32 v196 offset:2720
    ds_write_addtid_b32 v197 offset:5168
    ds_write_addtid_b32 v198 offset:6256
    ds_write_addtid_b32 v199 offset:2992
    ds_write_addtid_b32 v200 offset:6528
    s_cmp_lg_u32 s45, 0
    s_cbranch_scc1 A_NOU00
    s_add_u32 m0, s68, 0
    s_nop 0
    buffer_load_dwordx4 v241, s[52:55], s66 offen lds
    s_mov_b32 m0, s32
A_NOU00:
    s_cmp_lg_u32 s45, 1
    s_cbranch_scc1 A_NOU12
    s_add_u32 m0, s68, 1024
    s_nop 0
    buffer_load_dwordx4 v242, s[52:55], s66 offen lds
    s_add_u32 m0, s69, 1024
    s_nop 0
    buffer_load_dwordx4 v242, s[52:55], s67 offen lds
    s_mov_b32 m0, s32
A_NOU12:
    ds_read_b128 v[112:115], v79 offset:0
    ds_read_b128 v[116:119], v79 offset:32
    ds_read_b128 v[120:123], v79 offset:64
    ds_read_b128 v[124:127], v79 offset:96
    ds_read_b128 v[128:131], v79 offset:128
    ds_read_b128 v[132:135], v79 offset:160
    ds_read_b128 v[136:139], v79 offset:192
    ds_read_b128 v[140:143], v79 offset:224
    v_mov_b32 v72, 0
    v_mov_b32 v73, 0
    v_mov_b32 v74, 0
    v_mov_b32 v75, 0
    v_lshl_add_u32 v233, v1, 4, s32
    s_add_u32 s44, s32, 3360
    s_waitcnt lgkmcnt(7)
    v_mfma_f32_32x32x16_bf16 v[144:159], v[112:115], v[80:83], v[144:159]
    v_lshlrev_b32 v4, 1, v1
    v_sub_u32 v5, s44, v4
    s_waitcnt lgkmcnt(6)
    v_mfma_f32_32x32x16_bf16 v[144:159], v[116:119], v[84:87], v[144:159]
    v_add3_u32 v4, v4, s44, 2
    s_waitcnt lgkmcnt(5)
    v_mfma_f32_32x32x16_bf16 v[144:159], v[120:123], v[88:91], v[144:159]
    v_cndmask_b32 v234, v4, v5, s[60:61]
    s_waitcnt lgkmcnt(4)
    v_mfma_f32_32x32x16_bf16 v[144:159], v[124:127], v[92:95], v[144:159]
    v_add_u32 v4, 128, v4
    s_waitcnt lgkmcnt(3)
    s_nop 0
    v_mfma_f32_32x32x16_bf16 v[144:159], v[128:131], v[96:99], v[144:159]
    v_cndmask_b32 v235, v4, v5, s[60:61]
    s_add_u32 s44, s32, 7396
    s_waitcnt lgkmcnt(2)
    v_mfma_f32_32x32x16_bf16 v[144:159], v[132:135], v[100:103], v[144:159]
    v_lshl_add_u32 v255, v1, 2, s44
    s_waitcnt lgkmcnt(1)
    v_mfma_f32_32x32x16_bf16 v[144:159], v[136:139], v[104:107], v[144:159]
    v_and_b32 v4, 32, v1
    s_waitcnt lgkmcnt(0)
    v_mfma_f32_32x32x16_bf16 v[144:159], v[140:143], v[108:111], v[144:159]
    v_lshl_add_u32 v253, v4, 3, v255
    s_nop 10
    s_nop 0
    v_mov_b32_dpp v68, v152 wave_rol:1 row_mask:0xf bank_mask:0xf
    v_mov_b32_dpp v69, v154 wave_rol:1 row_mask:0xf bank_mask:0xf
    v_mov_b32_dpp v70, v155 wave_rol:1 row_mask:0xf bank_mask:0xf
    v_mov_b32_dpp v71, v156 wave_rol:1 row_mask:0xf bank_mask:0xf
    v_mov_b32_dpp v68, v144 wave_shl:1 row_mask:0xf bank_mask:0xf
    v_mov_b32_dpp v69, v152 wave_shl:1 row_mask:0xf bank_mask:0xf
    v_mov_b32_dpp v70, v154 wave_shl:1 row_mask:0xf bank_mask:0xf
    v_mov_b32_dpp v71, v155 wave_shl:1 row_mask:0xf bank_mask:0xf
    v_add_f32_e64 v144, v144, v45
    v_cndmask_b32 v151, v151, v68, s[50:51]
    v_cvt_pk_bf16_f32 v112, v145, v144
    v_cvt_pk_bf16_f32 v113, v147, v146
    v_cvt_pk_bf16_f32 v114, v149, v148
    v_cvt_pk_bf16_f32 v115, v151, v150
    ds_write_b128 v233, v[112:115] offset:32
    v_cvt_pk_bf16_f32 v116, v146, v145
    v_cvt_pk_bf16_f32 v117, v148, v147
    v_cvt_pk_bf16_f32 v118, v150, v149
    v_cvt_pk_bf16_f32 v119, v68, v151
    ds_write_b128 v233, v[116:119] offset:4192
    v_cvt_pk_bf16_f32 v24, v69, v153
    ds_write_b32 v253, v72
    ds_write_b32 v255, v24 offset:128
    v_cvt_pk_bf16_f32 v16, v70, v154
    v_cndmask_b32 v16, v16, v72, s[60:61]
    ds_write_b32 v234, v16
    v_cvt_pk_bf16_f32 v17, v71, v155
    v_cndmask_b32 v17, v17, v72, s[60:61]
    ds_write_b32 v235, v17
    s_mov_b64 exec, 63
    s_nop 0
    ds_write_b128 v233, v[72:75] offset:1056
    ds_write_b128 v233, v[72:75] offset:5216
    ds_write_b128 v233, v[72:75] offset:2048
    ds_write_b128 v233, v[72:75] offset:6208
    s_mov_b64 exec, 3
    ds_write_b128 v233, v[72:75]
    ds_write_b128 v233, v[72:75] offset:4160
    s_mov_b64 exec, 1
    v_cvt_pk_bf16_f32 v18, v152, v152
    v_cvt_pk_bf16_f32 v19, v72, v152
    v_cvt_pk_bf16_f32 v20, v144, v72
    v_cvt_pk_bf16_f32 v21, v154, v72
    v_cvt_pk_bf16_f32 v22, v72, v154
    v_cvt_pk_bf16_f32 v23, v154, v154
    ds_write_b32 v233, v20 offset:4188
    ds_write_b64 v233, v[18:19] offset:1056
    ds_write_b32 v233, v18 offset:5216
    ds_write_b32 v233, v21 offset:2084
    ds_write_b32 v233, v22 offset:2088
    ds_write_b32 v233, v23 offset:6244
    s_mov_b64 exec, -1
    s_cmp_eq_u32 s45, 2
    s_cbranch_scc1 A_NOUL
    s_cmp_eq_u32 s45, 1
    s_cbranch_scc1 A_ULE
    s_add_u32 m0, s69, 0
    s_nop 0
    buffer_load_dwordx4 v241, s[52:55], s67 offen lds
    s_add_u32 m0, s68, 1024
    s_nop 0
    buffer_load_dwordx4 v242, s[52:55], s66 offen lds
    s_add_u32 m0, s69, 1024
    s_nop 0
    buffer_load_dwordx4 v242, s[52:55], s67 offen lds
A_ULE:
    s_add_u32 m0, s68, 2048
    s_nop 0
    buffer_load_dwordx4 v243, s[52:55], s66 offen lds
    s_add_u32 m0, s69, 2048
    s_nop 0
    buffer_load_dwordx4 v243, s[52:55], s67 offen lds
    s_add_u32 m0, s68, 3072
    s_nop 0
    buffer_load_dwordx4 v244, s[52:55], s66 offen lds
    s_add_u32 m0, s69, 3072
    s_nop 0
    s_nop 0
    buffer_load_dwordx4 v244, s[52:55], s67 offen lds
A_NOUL:
    v_lshl_add_u32 v4, v1, 3, s33
    ds_write_b64 v4, v[72:73]
    v_lshlrev_b32_e64 v5, 10, v7
    v_lshl_add_u32 v5, v1, 4, v5
    v_xor_b32 v245, 0, v5
    v_add_u32 v245, s56, v245
    v_xor_b32 v246, 1024, v5
    v_add_u32_e64 v246, s56, v246
    v_xor_b32 v247, 2048, v5
    v_add_u32_e64 v247, s56, v247
    v_xor_b32 v248, 3072, v5
    v_add_u32 v248, s56, v248
    v_lshlrev_b32 v5, 3, v0
    v_add_u32 v236, 70144, v5
    v_and_b32 v2, 15, v1
    v_lshrrev_b32 v3, 4, v1
    v_lshrrev_b32 v6, 2, v2
    v_xor_b32 v6, v2, v6
    v_lshlrev_b32_e64 v5, 3, v3
    v_mov_b32 v4, 0x1ff0
    v_lshlrev_b32 v4, v6, v4
    v_lshrrev_b32 v4, v5, v4
    v_and_b32 v4, 0xff, v4
    v_lshl_or_b32 v4, v4, 15, v4
    v_lshrrev_b32_e64 v220, 0, v4
    v_and_b32 v220, 0x10001, v220
    v_mul_u32_u24 v220, 0x3f80, v220
    v_lshrrev_b32_e64 v221, 2, v4
    v_and_b32 v221, 0x10001, v221
    v_mul_u32_u24 v221, 0x3f80, v221
    v_lshrrev_b32_e64 v222, 4, v4
    v_and_b32 v222, 0x10001, v222
    v_mul_u32_u24 v222, 0x3f80, v222
    v_lshrrev_b32_e64 v223, 6, v4
    v_and_b32 v223, 0x10001, v223
    v_mul_u32_u24 v223, 0x3f80, v223
    v_mov_b32 v4, 0xfe0
    v_lshlrev_b32 v4, v6, v4
    v_lshrrev_b32 v4, v5, v4
    v_and_b32 v4, 0xff, v4
    v_lshl_or_b32 v4, v4, 15, v4
    v_lshrrev_b32_e64 v224, 0, v4
    v_and_b32 v224, 0x10001, v224
    v_mul_u32_u24 v224, 0x3f80, v224
    v_lshrrev_b32_e64 v225, 2, v4
    v_and_b32 v225, 0x10001, v225
    v_mul_u32_u24 v225, 0x3f80, v225
    v_lshrrev_b32_e64 v226, 4, v4
    v_and_b32 v226, 0x10001, v226
    v_mul_u32_u24 v226, 0x3f80, v226
    v_lshrrev_b32_e64 v227, 6, v4
    v_and_b32 v227, 0x10001, v227
    v_mul_u32_u24 v227, 0x3f80, v227
    v_mov_b32 v4, 0x7c0
    v_lshlrev_b32 v4, v6, v4
    v_lshrrev_b32 v4, v5, v4
    v_and_b32 v4, 0xff, v4
    v_lshl_or_b32 v4, v4, 15, v4
    v_lshrrev_b32_e64 v176, 0, v4
    v_and_b32 v176, 0x10001, v176
    v_mul_u32_u24 v176, 0x3f80, v176
    v_lshrrev_b32_e64 v177, 2, v4
    v_and_b32 v177, 0x10001, v177
    v_mul_u32_u24 v177, 0x3f80, v177
    v_lshrrev_b32_e64 v178, 4, v4
    v_and_b32 v178, 0x10001, v178
    v_mul_u32_u24 v178, 0x3f80, v178
    v_lshrrev_b32_e64 v179, 6, v4
    v_and_b32 v179, 0x10001, v179
    v_mul_u32_u24 v179, 0x3f80, v179
PG_A2:
    s_cbranch_execz PG_A_RET
    s_nop 0
    v_mov_b32 v4, 0x3800
    v_lshlrev_b32 v4, v6, v4
    v_lshrrev_b32 v4, v5, v4
    v_and_b32 v4, 0xff, v4
    v_lshl_or_b32 v4, v4, 15, v4
    v_lshrrev_b32_e64 v180, 0, v4
    v_and_b32 v180, 0x10001, v180
    v_mul_u32_u24 v180, 0x3f80, v180
    v_lshrrev_b32_e64 v181, 2, v4
    v_and_b32 v181, 0x10001, v181
    v_mul_u32_u24 v181, 0x3f80, v181
    v_lshrrev_b32_e64 v182, 4, v4
    v_and_b32 v182, 0x10001, v182
    v_mul_u32_u24 v182, 0x3f80, v182
    v_lshrrev_b32_e64 v183, 6, v4
    v_and_b32 v183, 0x10001, v183
    v_mul_u32_u24 v183, 0x3f80, v183
    v_and_b32_e64 v4, 1, v6
    v_mul_u32_u24 v4, 4156, v4
    v_lshrrev_b32 v6, 1, v6
    v_lshlrev_b32 v6, 2, v6
    v_sub_u32 v6, v6, v4
    v_lshlrev_b32 v5, 4, v3
    v_sub_u32_e64 v6, v6, v5
    s_add_u32 s44, s32, 4208
    v_add_u32_e64 v228, s44, v6
    v_add_u32 v229, 1024, v228
    v_add_u32 v230, 2048, v228
    v_lshlrev_b32 v4, 2, v2
    v_sub_u32 v4, v4, v5
    s_add_u32 s44, s32, 3352
    v_add_u32_e64 v232, s44, v4
    s_add_u32 s44, s32, 7500
    v_lshl_add_u32 v254, v4, 1, s44
    v_lshl_add_u32 v5, v2, 5, v5
    s_add_u32 s44, s33, 352
    v_add_u32_e64 v231, s44, v5
    s_bfe_u32 s57, s28, 0x30004
    s_and_b32 s58, s57, 1
    s_lshl_b32 s58, s58, 1
    s_lshr_b32 s59, s4, 2
    s_add_u32 s58, s58, s59
    s_mul_i32 s58, s58, 5
    s_and_b32 s59, s4, 3
    s_lshl_b32 s59, s59, 6
    s_add_u32 s58, s58, s59
    s_lshr_b32 s59, s57, 1
    s_lshl_b32 s59, s59, 9
    s_add_u32 s58, s58, s59
    v_bfe_u32 v4, v1, 3, 1
    v_lshlrev_b32 v4, 8, v4
    v_lshl_add_u32 v4, v3, 4, v4
    v_add_u32 v4, s58, v4
    v_and_b32 v5, 7, v1
    s_and_b32 s44, s28, 0xffffff80
    v_lshl_add_u32 v249, v5, 4, s44
    v_mul_u32_u24 v5, 4128, v5
    v_lshrrev_b32_e64 v6, 3, v0
    v_lshl_add_u32 v5, v6, 3, v5
    v_add_u32 v251, 106496, v5
    v_xor_b32_e64 v237, 0, v4
    v_mul_u32_u24 v237, 2560, v237
    v_add_u32 v237, v249, v237
    v_xor_b32 v238, 1, v4
    v_mul_u32_u24 v238, 2560, v238
    v_add_u32 v238, v249, v238
    v_xor_b32 v239, 2, v4
    v_mul_u32_u24 v239, 2560, v239
    v_add_u32 v239, v249, v239
    v_xor_b32 v240, 3, v4
    v_mul_u32_u24 v240, 2560, v240
    v_add_u32_e64 v240, v249, v240
    ds_read2_b32 v[64:65], v230 offset0:3 offset1:2
    ds_read2_b32 v[66:67], v230 offset0:1 offset1:0
    ds_read2_b32 v[68:69], v229 offset0:3 offset1:2
    ds_read2_b32 v[70:71], v229 offset0:1 offset1:0
    ds_read2_b32 v[80:81], v232 offset0:3 offset1:2
    ds_read2_b32 v[82:83], v232 offset0:1 offset1:0
    ds_read2_b32 v[84:85], v232 offset0:19 offset1:18
    ds_read2_b32 v[86:87], v232 offset0:17 offset1:16
    ds_read2_b32 v[88:89], v232 offset0:35 offset1:34
    ds_read2_b32 v[90:91], v232 offset0:33 offset1:32
    ds_read2_b32 v[92:93], v232 offset0:51 offset1:50
    ds_read2_b32 v[94:95], v232 offset0:49 offset1:48
    ds_read2_b32 v[208:209], v254 offset0:7 offset1:6
    ds_read2_b32 v[210:211], v254 offset0:5 offset1:4
    ds_read2_b32 v[212:213], v254 offset0:3 offset1:2
    ds_read2_b32 v[214:215], v254 offset0:1 offset1:0
    ds_read2_b32 v[216:217], v254 offset0:39 offset1:38
    ds_read2_b32 v[218:219], v254 offset0:37 offset1:36
    ds_read2_b32 v[8:9], v254 offset0:35 offset1:34
    ds_read2_b32 v[10:11], v254 offset0:33 offset1:32
    ds_read2_b32 v[12:13], v254 offset0:71 offset1:70
    ds_read2_b32 v[14:15], v254 offset0:69 offset1:68
    ds_read2_b32 v[76:77], v254 offset0:67 offset1:66
    ds_read2_b32 v[78:79], v254 offset0:65 offset1:64
    ds_read2_b32 v[16:17], v228 offset0:3 offset1:2
    ds_read2_b32 v[18:19], v228 offset0:1 offset1:0
    ds_read2_b32 v[20:21], v228 offset0:131 offset1:130
    ds_read2_b32 v[22:23], v228 offset0:129 offset1:128
    v_pk_mov_b32 v[144:145], v[72:73], v[72:73]
    v_pk_mov_b32 v[146:147], v[72:73], v[72:73]
    v_pk_mov_b32 v[148:149], v[72:73], v[72:73]
    v_pk_mov_b32 v[150:151], v[72:73], v[72:73]
    global_load_dword v252, v72, s[36:37] offset:28 sc1
    s_cmp_ge_u32 s4, 4
    s_cbranch_scc1 A_NOUT
    s_waitcnt vmcnt(1)
    s_nop 0
    ds_read_b128 v[32:35], v245 offset:0
    ds_read_b128 v[36:39], v246 offset:0
    ds_read_b128 v[40:43], v247 offset:0
    ds_read_b128 v[44:47], v248 offset:0
    ds_read_b128 v[48:51], v245 offset:16384
    ds_read_b128 v[52:55], v246 offset:16384
    ds_read_b128 v[56:59], v247 offset:16384
    ds_read_b128 v[60:63], v248 offset:16384
    s_waitcnt lgkmcnt(4)
    s_nop 0
    v_perm_b32 v112, v36, v32, s42
    v_perm_b32 v113, v44, v40, s42
    ds_write_b64 v236, v[112:113] offset:0
    v_perm_b32 v114, v36, v32, s43
    v_perm_b32 v115, v44, v40, s43
    ds_write_b64 v236, v[114:115] offset:4608
    v_perm_b32 v116, v37, v33, s42
    v_perm_b32 v117, v45, v41, s42
    ds_write_b64 v236, v[116:117] offset:9216
    v_perm_b32 v118, v37, v33, s43
    v_perm_b32 v119, v45, v41, s43
    ds_write_b64 v236, v[118:119] offset:13824
    v_perm_b32 v120, v38, v34, s42
    v_perm_b32 v121, v46, v42, s42
    ds_write_b64 v236, v[120:121] offset:18432
    v_perm_b32 v122, v38, v34, s43
    v_perm_b32 v123, v46, v42, s43
    ds_write_b64 v236, v[122:123] offset:23040
    v_perm_b32 v124, v39, v35, s42
    v_perm_b32 v125, v47, v43, s42
    ds_write_b64 v236, v[124:125] offset:27648
    v_perm_b32 v126, v39, v35, s43
    v_perm_b32 v127, v47, v43, s43
    ds_write_b64 v236, v[126:127] offset:32256
    s_waitcnt lgkmcnt(8)
    s_nop 0
    v_perm_b32 v128, v52, v48, s42
    v_perm_b32 v129, v60, v56, s42
    ds_write_b64 v236, v[128:129] offset:2048
    v_perm_b32 v130, v52, v48, s43
    v_perm_b32 v131, v60, v56, s43
    ds_write_b64 v236, v[130:131] offset:6656
    v_perm_b32 v132, v53, v49, s42
    v_perm_b32 v133, v61, v57, s42
    ds_write_b64 v236, v[132:133] offset:11264
    v_perm_b32 v134, v53, v49, s43
    v_perm_b32 v135, v61, v57, s43
    ds_write_b64 v236, v[134:135] offset:15872
    v_perm_b32 v136, v54, v50, s42
    v_perm_b32 v137, v62, v58, s42
    ds_write_b64 v236, v[136:137] offset:20480
    v_perm_b32 v138, v54, v50, s43
    v_perm_b32 v139, v62, v58, s43
    ds_write_b64 v236, v[138:139] offset:25088
    v_perm_b32 v140, v55, v51, s42
    v_perm_b32 v141, v63, v59, s42
    ds_write_b64 v236, v[140:141] offset:29696
    v_perm_b32 v142, v55, v51, s43
    v_perm_b32 v143, v63, v59, s43
    ds_write_b64 v236, v[142:143] offset:34304
A_NOUT:
    s_waitcnt lgkmcnt(0)
    s_barrier
    ds_read_b128 v[32:35], v231 offset:128
    ds_read_b128 v[184:187], v231 offset:112
    ds_read_b128 v[36:39], v231 offset:640
    ds_read_b128 v[188:191], v231 offset:624
    ds_read_b128 v[40:43], v231 offset:1152
    ds_read_b128 v[192:195], v231 offset:1136
    ds_read_b128 v[44:47], v231 offset:1664
    ds_read_b128 v[196:199], v231 offset:1648
    ds_read_b128 v[48:51], v231 offset:2176
    ds_read_b128 v[200:203], v231 offset:2160
    ds_read_b128 v[52:55], v231 offset:2688
    ds_read_b128 v[204:207], v231 offset:2672
    ds_read_b128 v[56:59], v231 offset:3200
    ds_read_b128 v[60:63], v231 offset:3712
    s_waitcnt lgkmcnt(12)
    s_nop 0
    v_mfma_f32_16x16x32_bf16 v[96:99], v[184:187], v[176:179], 0
    v_mfma_f32_16x16x32_bf16 v[100:103], v[184:187], v[180:183], 0
    v_mfma_f32_16x16x32_bf16 v[104:107], v[32:35], v[176:179], 0
    v_mfma_f32_16x16x32_bf16 v[108:111], v[32:35], v[180:183], 0
    v_mfma_f32_16x16x32_bf16 v[112:115], v[184:187], v[220:223], 0
    v_mfma_f32_16x16x32_bf16 v[116:119], v[32:35], v[224:227], 0
    s_waitcnt lgkmcnt(2)
    s_nop 0
    v_mfma_f32_16x16x32_bf16 v[152:155], v[68:71], v[32:35], 0
    v_mfma_f32_16x16x32_bf16 v[156:159], v[68:71], v[36:39], 0
    v_mfma_f32_16x16x32_bf16 v[160:163], v[68:71], v[40:43], 0
    v_mfma_f32_16x16x32_bf16 v[164:167], v[68:71], v[44:47], 0
    v_mfma_f32_16x16x32_bf16 v[168:171], v[68:71], v[48:51], 0
    v_mfma_f32_16x16x32_bf16 v[172:175], v[68:71], v[52:55], 0
    v_mfma_f32_16x16x32_bf16 v[160:163], v[64:67], v[32:35], v[160:163]
    v_mfma_f32_16x16x32_bf16 v[164:167], v[64:67], v[36:39], v[164:167]
    v_mfma_f32_16x16x32_bf16 v[168:171], v[64:67], v[40:43], v[168:171]
    v_mfma_f32_16x16x32_bf16 v[172:175], v[64:67], v[44:47], v[172:175]
    v_mfma_f32_16x16x32_bf16 v[120:123], v[188:191], v[176:179], 0
    v_cvt_pk_bf16_f32 v24, v96, v100
    v_cvt_pk_bf16_f32 v25, v104, v108
    v_mfma_f32_16x16x32_bf16 v[124:127], v[188:191], v[180:183], 0
    v_cvt_pk_bf16_f32 v26, v97, v101
    v_cvt_pk_bf16_f32 v27, v105, v109
    v_mfma_f32_16x16x32_bf16 v[128:131], v[36:39], v[176:179], 0
    v_cvt_pk_bf16_f32 v28, v98, v102
    v_cvt_pk_bf16_f32 v29, v106, v110
    v_mfma_f32_16x16x32_bf16 v[132:135], v[36:39], v[180:183], 0
    v_cvt_pk_bf16_f32 v30, v99, v103
    v_cvt_pk_bf16_f32 v31, v107, v111
    v_mfma_f32_16x16x32_bf16 v[136:139], v[188:191], v[220:223], 0
    v_cvt_pk_bf16_f32 v242, v112, v116
    v_cvt_pk_bf16_f32 v243, v113, v117
    v_mfma_f32_16x16x32_bf16 v[140:143], v[36:39], v[224:227], 0
    v_cvt_pk_bf16_f32 v244, v114, v118
    v_cvt_pk_bf16_f32 v245, v115, v119
    v_mfma_f32_16x16x32_bf16 v[152:155], v[24:27], v[208:211], v[152:155]
    v_mfma_f32_16x16x32_bf16 v[156:159], v[24:27], v[216:219], v[156:159]
    v_mfma_f32_16x16x32_bf16 v[160:163], v[24:27], v[12:15], v[160:163]
    v_mfma_f32_16x16x32_bf16 v[152:155], v[28:31], v[212:215], v[152:155]
    v_mfma_f32_16x16x32_bf16 v[156:159], v[28:31], v[8:11], v[156:159]
    v_mfma_f32_16x16x32_bf16 v[160:163], v[28:31], v[76:79], v[160:163]
    v_mfma_f32_16x16x32_bf16 v[160:163], v[242:245], v[80:83], v[160:163]
    v_mfma_f32_16x16x32_bf16 v[164:167], v[242:245], v[84:87], v[164:167]
    v_mfma_f32_16x16x32_bf16 v[168:171], v[242:245], v[88:91], v[168:171]
    v_mfma_f32_16x16x32_bf16 v[172:175], v[242:245], v[92:95], v[172:175]
    v_mfma_f32_16x16x32_bf16 v[96:99], v[192:195], v[176:179], 0
    v_cvt_pk_bf16_f32 v24, v120, v124
    v_cvt_pk_bf16_f32 v25, v128, v132
    v_mfma_f32_16x16x32_bf16 v[100:103], v[192:195], v[180:183], 0
    v_cvt_pk_bf16_f32 v26, v121, v125
    v_cvt_pk_bf16_f32 v27, v129, v133
    v_mfma_f32_16x16x32_bf16 v[104:107], v[40:43], v[176:179], 0
    v_cvt_pk_bf16_f32 v28, v122, v126
    v_cvt_pk_bf16_f32 v29, v130, v134
    v_mfma_f32_16x16x32_bf16 v[108:111], v[40:43], v[180:183], 0
    v_cvt_pk_bf16_f32 v30, v123, v127
    v_cvt_pk_bf16_f32 v31, v131, v135
    v_mfma_f32_16x16x32_bf16 v[112:115], v[192:195], v[220:223], 0
    v_cvt_pk_bf16_f32 v242, v136, v140
    v_cvt_pk_bf16_f32 v243, v137, v141
    v_mfma_f32_16x16x32_bf16 v[116:119], v[40:43], v[224:227], 0
    v_cvt_pk_bf16_f32 v244, v138, v142
    v_cvt_pk_bf16_f32 v245, v139, v143
    v_mfma_f32_16x16x32_bf16 v[156:159], v[24:27], v[208:211], v[156:159]
    v_mfma_f32_16x16x32_bf16 v[160:163], v[24:27], v[216:219], v[160:163]
    v_mfma_f32_16x16x32_bf16 v[164:167], v[24:27], v[12:15], v[164:167]
    v_mfma_f32_16x16x32_bf16 v[156:159], v[28:31], v[212:215], v[156:159]
    v_mfma_f32_16x16x32_bf16 v[160:163], v[28:31], v[8:11], v[160:163]
    v_mfma_f32_16x16x32_bf16 v[164:167], v[28:31], v[76:79], v[164:167]
    v_mfma_f32_16x16x32_bf16 v[164:167], v[242:245], v[80:83], v[164:167]
    v_mfma_f32_16x16x32_bf16 v[168:171], v[242:245], v[84:87], v[168:171]
    v_mfma_f32_16x16x32_bf16 v[172:175], v[242:245], v[88:91], v[172:175]
    v_mfma_f32_16x16x32_bf16 v[120:123], v[196:199], v[176:179], 0
    v_cvt_pk_bf16_f32 v24, v96, v100
    v_cvt_pk_bf16_f32 v25, v104, v108
    v_mfma_f32_16x16x32_bf16 v[124:127], v[196:199], v[180:183], 0
    v_cvt_pk_bf16_f32 v26, v97, v101
    v_cvt_pk_bf16_f32 v27, v105, v109
    v_mfma_f32_16x16x32_bf16 v[128:131], v[44:47], v[176:179], 0
    v_cvt_pk_bf16_f32 v28, v98, v102
    v_cvt_pk_bf16_f32 v29, v106, v110
    v_mfma_f32_16x16x32_bf16 v[132:135], v[44:47], v[180:183], 0
    v_cvt_pk_bf16_f32 v30, v99, v103
    v_cvt_pk_bf16_f32 v31, v107, v111
    v_mfma_f32_16x16x32_bf16 v[136:139], v[196:199], v[220:223], 0
    v_cvt_pk_bf16_f32 v242, v112, v116
    v_cvt_pk_bf16_f32 v243, v113, v117
    v_mfma_f32_16x16x32_bf16 v[140:143], v[44:47], v[224:227], 0
    v_cvt_pk_bf16_f32 v244, v114, v118
    v_cvt_pk_bf16_f32 v245, v115, v119
    v_mfma_f32_16x16x32_bf16 v[160:163], v[24:27], v[208:211], v[160:163]
    v_mfma_f32_16x16x32_bf16 v[164:167], v[24:27], v[216:219], v[164:167]
    v_mfma_f32_16x16x32_bf16 v[168:171], v[24:27], v[12:15], v[168:171]
    v_mfma_f32_16x16x32_bf16 v[160:163], v[28:31], v[212:215], v[160:163]
    v_mfma_f32_16x16x32_bf16 v[164:167], v[28:31], v[8:11], v[164:167]
    v_mfma_f32_16x16x32_bf16 v[168:171], v[28:31], v[76:79], v[168:171]
    v_mfma_f32_16x16x32_bf16 v[168:171], v[242:245], v[80:83], v[168:171]
    v_mfma_f32_16x16x32_bf16 v[172:175], v[242:245], v[84:87], v[172:175]
    v_mfma_f32_16x16x32_bf16 v[96:99], v[200:203], v[176:179], 0
    v_cvt_pk_bf16_f32 v24, v120, v124
    v_cvt_pk_bf16_f32 v25, v128, v132
    v_cvt_pk_bf16_f32 v26, v121, v125
    v_mfma_f32_16x16x32_bf16 v[100:103], v[200:203], v[180:183], 0
    v_cvt_pk_bf16_f32 v27, v129, v133
    v_cvt_pk_bf16_f32 v28, v122, v126
    v_cvt_pk_bf16_f32 v29, v130, v134
    v_mfma_f32_16x16x32_bf16 v[104:107], v[48:51], v[176:179], 0
    v_cvt_pk_bf16_f32 v30, v123, v127
    v_cvt_pk_bf16_f32 v31, v131, v135
    v_cvt_pk_bf16_f32 v242, v136, v140
    v_mfma_f32_16x16x32_bf16 v[108:111], v[48:51], v[180:183], 0
    v_cvt_pk_bf16_f32 v243, v137, v141
    v_cvt_pk_bf16_f32 v244, v138, v142
    v_cvt_pk_bf16_f32 v245, v139, v143
    v_mfma_f32_16x16x32_bf16 v[164:167], v[24:27], v[208:211], v[164:167]
    v_mfma_f32_16x16x32_bf16 v[168:171], v[24:27], v[216:219], v[168:171]
    v_mfma_f32_16x16x32_bf16 v[172:175], v[24:27], v[12:15], v[172:175]
    v_mfma_f32_16x16x32_bf16 v[164:167], v[28:31], v[212:215], v[164:167]
    v_mfma_f32_16x16x32_bf16 v[168:171], v[28:31], v[8:11], v[168:171]
    v_mfma_f32_16x16x32_bf16 v[172:175], v[28:31], v[76:79], v[172:175]
    v_mfma_f32_16x16x32_bf16 v[172:175], v[242:245], v[80:83], v[172:175]
    v_mfma_f32_16x16x32_bf16 v[120:123], v[204:207], v[176:179], 0
    v_cvt_pk_bf16_f32 v24, v96, v100
    v_cvt_pk_bf16_f32 v25, v104, v108
    v_mfma_f32_16x16x32_bf16 v[124:127], v[204:207], v[180:183], 0
    v_cvt_pk_bf16_f32 v26, v97, v101
    v_cvt_pk_bf16_f32 v27, v105, v109
    v_mfma_f32_16x16x32_bf16 v[128:131], v[52:55], v[176:179], 0
    v_cvt_pk_bf16_f32 v28, v98, v102
    v_cvt_pk_bf16_f32 v29, v106, v110
    v_mfma_f32_16x16x32_bf16 v[132:135], v[52:55], v[180:183], 0
    v_cvt_pk_bf16_f32 v30, v99, v103
    v_cvt_pk_bf16_f32 v31, v107, v111
    v_mfma_f32_16x16x32_bf16 v[168:171], v[24:27], v[208:211], v[168:171]
    v_mfma_f32_16x16x32_bf16 v[172:175], v[24:27], v[216:219], v[172:175]
    v_mfma_f32_16x16x32_bf16 v[168:171], v[28:31], v[212:215], v[168:171]
    v_mfma_f32_16x16x32_bf16 v[172:175], v[28:31], v[8:11], v[172:175]
    v_cvt_pk_bf16_f32 v24, v120, v124
    s_nop 0
    s_nop 0
    v_cvt_pk_bf16_f32 v25, v128, v132
    v_cvt_pk_bf16_f32 v26, v121, v125
    v_cvt_pk_bf16_f32 v27, v129, v133
    v_cvt_pk_bf16_f32 v28, v122, v126
    v_cvt_pk_bf16_f32 v29, v130, v134
    v_cvt_pk_bf16_f32 v30, v123, v127
    v_cvt_pk_bf16_f32 v31, v131, v135
    v_mfma_f32_16x16x32_bf16 v[172:175], v[24:27], v[208:211], v[172:175]
    s_nop 0
    v_mfma_f32_16x16x32_bf16 v[172:175], v[28:31], v[212:215], v[172:175]
    s_mov_b32 s41, 0
A_CONV:
    s_waitcnt lgkmcnt(0)
    s_nop 0
    v_mfma_f32_16x16x32_bf16 v[144:147], v[16:19], v[32:35], v[144:147]
    ds_read_b128 v[96:99], v231 offset:64
    v_mfma_f32_16x16x32_bf16 v[148:151], v[16:19], v[36:39], v[148:151]
    ds_read2_b32 v[24:25], v228 offset0:19 offset1:18
    v_mfma_f32_16x16x32_bf16 v[152:155], v[16:19], v[40:43], v[152:155]
    ds_read2_b32 v[26:27], v228 offset0:17 offset1:16
    v_mfma_f32_16x16x32_bf16 v[156:159], v[16:19], v[44:47], v[156:159]
    ds_read_b128 v[100:103], v231 offset:576
    v_mfma_f32_16x16x32_bf16 v[160:163], v[16:19], v[48:51], v[160:163]
    ds_read2_b32 v[28:29], v228 offset0:147 offset1:146
    v_mfma_f32_16x16x32_bf16 v[164:167], v[16:19], v[52:55], v[164:167]
    ds_read2_b32 v[30:31], v228 offset0:145 offset1:144
    v_mfma_f32_16x16x32_bf16 v[168:171], v[16:19], v[56:59], v[168:171]
    ds_read_b128 v[104:107], v231 offset:1088
    v_mfma_f32_16x16x32_bf16 v[172:175], v[16:19], v[60:63], v[172:175]
    ds_read_b128 v[108:111], v231 offset:1600
    v_mfma_f32_16x16x32_bf16 v[148:151], v[20:23], v[32:35], v[148:151]
    ds_read_b128 v[112:115], v231 offset:2112
    v_mfma_f32_16x16x32_bf16 v[152:155], v[20:23], v[36:39], v[152:155]
    ds_read_b128 v[116:119], v231 offset:2624
    v_mfma_f32_16x16x32_bf16 v[156:159], v[20:23], v[40:43], v[156:159]
    ds_read_b128 v[120:123], v231 offset:3136
    v_mfma_f32_16x16x32_bf16 v[160:163], v[20:23], v[44:47], v[160:163]
    ds_read_b128 v[124:127], v231 offset:3648
    v_mfma_f32_16x16x32_bf16 v[164:167], v[20:23], v[48:51], v[164:167]
    v_mfma_f32_16x16x32_bf16 v[168:171], v[20:23], v[52:55], v[168:171]
    v_mfma_f32_16x16x32_bf16 v[172:175], v[20:23], v[56:59], v[172:175]
    s_waitcnt lgkmcnt(0)
    s_nop 0
    v_mfma_f32_16x16x32_bf16 v[144:147], v[24:27], v[96:99], v[144:147]
    ds_read_b128 v[32:35], v231 offset:0
    v_mfma_f32_16x16x32_bf16 v[148:151], v[24:27], v[100:103], v[148:151]
    ds_read2_b32 v[16:17], v228 offset0:35 offset1:34
    v_mfma_f32_16x16x32_bf16 v[152:155], v[24:27], v[104:107], v[152:155]
    ds_read2_b32 v[18:19], v228 offset0:33 offset1:32
    v_mfma_f32_16x16x32_bf16 v[156:159], v[24:27], v[108:111], v[156:159]
    ds_read_b128 v[36:39], v231 offset:512
    v_mfma_f32_16x16x32_bf16 v[160:163], v[24:27], v[112:115], v[160:163]
    ds_read2_b32 v[20:21], v228 offset0:163 offset1:162
    v_mfma_f32_16x16x32_bf16 v[164:167], v[24:27], v[116:119], v[164:167]
    ds_read2_b32 v[22:23], v228 offset0:161 offset1:160
    v_mfma_f32_16x16x32_bf16 v[168:171], v[24:27], v[120:123], v[168:171]
    ds_read_b128 v[40:43], v231 offset:1024
    v_mfma_f32_16x16x32_bf16 v[172:175], v[24:27], v[124:127], v[172:175]
    ds_read_b128 v[44:47], v231 offset:1536
    v_mfma_f32_16x16x32_bf16 v[148:151], v[28:31], v[96:99], v[148:151]
    ds_read_b128 v[48:51], v231 offset:2048
    v_mfma_f32_16x16x32_bf16 v[152:155], v[28:31], v[100:103], v[152:155]
    ds_read_b128 v[52:55], v231 offset:2560
    v_mfma_f32_16x16x32_bf16 v[156:159], v[28:31], v[104:107], v[156:159]
    ds_read_b128 v[56:59], v231 offset:3072
    v_mfma_f32_16x16x32_bf16 v[160:163], v[28:31], v[108:111], v[160:163]
    ds_read_b128 v[60:63], v231 offset:3584
    v_mfma_f32_16x16x32_bf16 v[164:167], v[28:31], v[112:115], v[164:167]
    v_add_u32 v228, 128, v228
    v_mfma_f32_16x16x32_bf16 v[168:171], v[28:31], v[116:119], v[168:171]
    v_subrev_u32 v231, 128, v231
    v_mfma_f32_16x16x32_bf16 v[172:175], v[28:31], v[120:123], v[172:175]
    s_add_u32 s41, s41, 1
    s_cmp_lt_u32 s41, 4
    s_cbranch_scc1 A_CONV
    s_mov_b32 s52, s62
    s_mov_b32 s53, s63
    s_mov_b32 s54, 9961472
    s_mov_b32 s55, 0x20000
    s_lshl_b32 s44, s29, 12
    s_add_u32 s44, s44, 7340032
    v_lshlrev_b32_e64 v2, 4, v1
    v_cvt_pk_bf16_f32 v184, v144, v145
    v_cvt_pk_bf16_f32 v185, v146, v147
    v_cvt_pk_bf16_f32 v186, v148, v149
    v_cvt_pk_bf16_f32 v187, v150, v151
    buffer_store_dwordx4 v[184:187], v2, s[52:55], s44 offen offset:0 sc1
    v_cvt_pk_bf16_f32 v188, v152, v153
    v_cvt_pk_bf16_f32 v189, v154, v155
    v_cvt_pk_bf16_f32 v190, v156, v157
    v_cvt_pk_bf16_f32 v191, v158, v159
    buffer_store_dwordx4 v[188:191], v2, s[52:55], s44 offen offset:1024 sc1
    v_cvt_pk_bf16_f32 v192, v160, v161
    v_cvt_pk_bf16_f32 v193, v162, v163
    v_cvt_pk_bf16_f32 v194, v164, v165
    v_cvt_pk_bf16_f32 v195, v166, v167
    buffer_store_dwordx4 v[192:195], v2, s[52:55], s44 offen offset:2048 sc1
    v_cvt_pk_bf16_f32 v196, v168, v169
    v_cvt_pk_bf16_f32 v197, v170, v171
    v_cvt_pk_bf16_f32 v198, v172, v173
    v_cvt_pk_bf16_f32 v199, v174, v175
    buffer_store_dwordx4 v[196:199], v2, s[52:55], s44 offen offset:3072 sc1
    v_mov_b32 v4, 0
    v_mov_b32_e64 v5, 2
    s_lshl_b32 s58, s28, 3
    s_add_u32 s58, s58, 24576
    s_and_b32 s59, s28, 0xffffff80
    s_lshr_b32 s59, s59, 4
    s_add_u32 s59, s59, s4
    s_lshl_b32 s45, s59, 7
    s_add_u32 s45, s45, 24576
    s_lshl_b32 s59, s59, 15
    s_lshl_b32 s57, s57, 9
    s_add_u32 s59, s59, s57
    s_add_u32 s59, s59, 7340032
    s_mul_i32 s57, s4, 4128
    s_add_u32 s57, s57, 106496
    v_lshrrev_b32_e64 v3, 5, v1
    v_mul_u32_u24 v3, 3584, v3
    v_add_u32 v3, v3, v2
    s_mov_b32 s41, 0
    s_mov_b64 exec, 1
    s_waitcnt vmcnt(0) lgkmcnt(0)
A_INIT:
    v_cmp_ne_u32 vcc, 0, v252
    s_cbranch_vccnz A_INIT_X
    global_load_dword v252, v4, s[36:37] offset:28 sc1
    s_add_u32 s41, s41, 1
    s_cmp_gt_u32 s41, 200000
    s_waitcnt vmcnt(0)
    s_cbranch_scc0 A_INIT
A_INIT_X:
    s_barrier
    s_cmp_lg_u32 s4, 0
    s_cbranch_scc1 A_POLL
    buffer_store_dword v5, v4, s[52:55], s58 offen sc1
A_POLL:
    v_mov_b32_e64 v6, 0
    buffer_atomic_or v6, v4, s[52:55], s45 offen sc0 sc1
    s_add_u32 s41, s41, 1
    s_cmp_gt_u32 s41, 200000
    s_waitcnt vmcnt(0)
    s_cbranch_scc1 A_POLL_X
    v_cmp_ne_u32 vcc, 2, v6
    s_cbranch_vccnz A_POLL
A_POLL_X:
    s_mov_b64 exec, -1
    s_add_u32 m0, s57, 0
    s_add_u32 s44, s59, 0
    buffer_load_dwordx4 v3, s[52:55], s44 offen sc1 lds
    s_add_u32 m0, s57, 1024
    s_add_u32 s44, s59, 8192
    buffer_load_dwordx4 v3, s[52:55], s44 offen sc1 lds
    s_add_u32 m0, s57, 2048
    s_add_u32 s44, s59, 16384
    buffer_load_dwordx4 v3, s[52:55], s44 offen sc1 lds
    s_add_u32 m0, s57, 3072
    s_add_u32 s44, s59, 24576
    buffer_load_dwordx4 v3, s[52:55], s44 offen sc1 lds
    s_waitcnt vmcnt(0)
    s_barrier
    ds_read_b64 v[48:49], v251 offset:0
    ds_read_b64 v[50:51], v251 offset:512
    ds_read_b64 v[52:53], v251 offset:1024
    ds_read_b64 v[54:55], v251 offset:1536
    ds_read_b64 v[56:57], v251 offset:2048
    ds_read_b64 v[58:59], v251 offset:2560
    ds_read_b64 v[60:61], v251 offset:3072
    ds_read_b64 v[62:63], v251 offset:3584
    s_waitcnt lgkmcnt(0)
    s_nop 0
    v_perm_b32 v80, v50, v48, s42
    v_perm_b32 v81, v54, v52, s42
    v_perm_b32 v82, v58, v56, s42
    v_perm_b32 v83, v62, v60, s42
    global_store_dwordx4 v237, v[80:83], s[26:27] sc1
    v_perm_b32 v84, v50, v48, s43
    v_perm_b32 v85, v54, v52, s43
    v_perm_b32 v86, v58, v56, s43
    v_perm_b32 v87, v62, v60, s43
    global_store_dwordx4 v238, v[84:87], s[26:27] sc1
    v_perm_b32 v88, v51, v49, s42
    v_perm_b32 v89, v55, v53, s42
    v_perm_b32 v90, v59, v57, s42
    v_perm_b32 v91, v63, v61, s42
    global_store_dwordx4 v239, v[88:91], s[26:27] sc1
    v_perm_b32 v92, v51, v49, s43
    v_perm_b32 v93, v55, v53, s43
    v_perm_b32 v94, v59, v57, s43
    v_perm_b32 v95, v63, v61, s43
    global_store_dwordx4 v240, v[92:95], s[26:27] sc1
L_END:
    s_endpgm
.section .rodata,"a"
.p2align 6
.amdhsa_kernel concat_heads__ssm_conv_s4__linear_kernel_hedgehog__prompt_kernel
  .amdhsa_next_free_vgpr 256
  .amdhsa_next_free_sgpr 102
  .amdhsa_accum_offset 256
  .amdhsa_group_segment_fixed_size 0
  .amdhsa_kernarg_size 128
  .amdhsa_user_sgpr_count 2
  .amdhsa_user_sgpr_kernarg_segment_ptr 1
  .amdhsa_system_sgpr_workgroup_id_x 1
.end_amdhsa_kernel
```
